```python
import torch

def _softmax(x, axis=-1):
    return torch.softmax(x, dim=axis)
def _gelu(x):
    return torch.nn.functional.gelu(x, approximate="tanh")
def _silu(x):
    return torch.nn.functional.silu(x)
def _sigmoid(x):
    return torch.sigmoid(x)
def _layernorm(x, axis=-1, eps=1e-5):
    m = x.mean(dim=axis, keepdim=True)
    v = x.var(dim=axis, keepdim=True, unbiased=False)
    return (x - m) / torch.sqrt(v + eps)
def _scatter_add(tgt, idx, src, axis=0):
    return tgt.clone().index_add_(axis, idx, src)
def _segment_sum(src, seg, n):
    out = torch.zeros((n,) + src.shape[1:], dtype=src.dtype)
    return out.index_add_(0, seg, src)
def _pad(x, pw):
    flat = tuple(v for pair in reversed(pw) for v in pair)
    return torch.nn.functional.pad(x, flat)

kernel_name = 'sequential_preLN__ssm_conv_h3__glu_gated_reglu__prompt'

def setup_inputs():

    _w = (lambda a: (lambda t: t.to(torch.bfloat16) if t.is_floating_point() else t)(torch.as_tensor(a)))
    def _A_setup():
        B, S, D = 1, 2048, 640
        ks = 4
        return {
            "q": _w((lambda *s: torch.randn(*s, dtype=torch.bfloat16) * 0.05)(B, S, D)),
            "k": _w((lambda *s: torch.randn(*s, dtype=torch.bfloat16) * 0.2)(B, S, D)),
            "v": _w((lambda *s: torch.randn(*s, dtype=torch.bfloat16) * 0.2)(B, S, D)),
            "shift_k": _w((lambda *s: torch.randn(*s, dtype=torch.bfloat16) * 0.2)(D, ks) * 0.5),
            "ssm_k": _w((lambda *s: torch.randn(*s, dtype=torch.bfloat16) * 0.4)(D, S) * (1.0 / S ** 0.5)),
            "ssm_D": _w((lambda *s: torch.randn(*s, dtype=torch.bfloat16) * 0.2)(D)),
        }
    _A_in = _A_setup()

    def _B_setup():
        B, S, D, F = 1, 2048, 640, 1536
        return {
            "x": _w((lambda *s: torch.randn(*s, dtype=torch.bfloat16) * 0.05)(B, S, D)),
            "W_gate": _w((lambda *s: torch.randn(*s, dtype=torch.bfloat16) * 0.2)(D, F) * (2.0 / D) ** 0.5),
            "W_up": _w((lambda *s: torch.randn(*s, dtype=torch.bfloat16) * 0.2)(D, F) * (2.0 / D) ** 0.5),
            "W_down": _w((lambda *s: torch.randn(*s, dtype=torch.bfloat16) * 0.2)(F, D) * (1.0 / F) ** 0.5),
        }
    _B_in = _B_setup()

    return {
        "A_q": _A_in["q"],
        "A_k": _A_in["k"],
        "A_v": _A_in["v"],
        "A_shift_k": _A_in["shift_k"],
        "A_ssm_k": _A_in["ssm_k"],
        "A_ssm_D": _A_in["ssm_D"],
        "B_x": _B_in["x"],
        "B_W_gate": _B_in["W_gate"],
        "B_W_up": _B_in["W_up"],
        "B_W_down": _B_in["W_down"],
    }

def reference(A_q, A_k, A_v, A_shift_k, A_ssm_k, A_ssm_D, B_x, B_W_gate, B_W_up, B_W_down):
    def _A_ref(q, k, v, shift_k, ssm_k, ssm_D):
        B, S, D = q.shape
        ks = shift_k.shape[-1]
        k_pad = _pad(k, ((0, 0), (ks - 1, 0), (0, 0)))
        k_shift = torch.zeros_like(k)
        for t in range(ks):
            k_shift = k_shift + k_pad[:, t:t + S, :] * shift_k[:, ks - 1 - t][None, None, :]
        kv = k_shift * v
        L = 2 * S
        kv_pad = _pad(kv, ((0, 0), (0, S), (0, 0)))
        kf_pad = _pad(ssm_k, ((0, 0), (0, S)))
        kv_f = (lambda x, axes=(-2,-1): torch.fft.rfft2(x.float(), dim=axes))(kv_pad[:, None, :, :], axes=(1, 2))
        kf_f = (lambda x, axes=(-2,-1): torch.fft.rfft2(x.float(), dim=axes))(kf_pad[:, None, :], axes=(1, 2))
        kf_f = (lambda x, *d: x.permute(*d))(kf_f, 1, 2, 0)
        y_f = kv_f * kf_f[None, :, :, :]
        y = (lambda x, s, axes=(-2,-1): torch.fft.irfft2(x, s=s, dim=axes).to(torch.bfloat16))(y_f, (1, L), axes=(1, 2))[:, 0, :S, :]
        y = y + kv * ssm_D[None, None, :]
        return q * y

    def _B_ref(x, W_gate, W_up, W_down):
        gate = torch.einsum("bsd,df->bsf", x, W_gate)
        up = torch.einsum("bsd,df->bsf", x, W_up)
        gate = gate * (lambda x, dt: x.to(dt))(gate > 0, gate.dtype)
        h = gate * up
        return torch.einsum("bsf,fd->bsd", h, W_down)

    x = A_q
    h = x + _A_ref(_layernorm(x, axis=-1), A_k, A_v, A_shift_k, A_ssm_k, A_ssm_D)
    h2 = h + _B_ref(_layernorm(h, axis=-1), B_W_gate, B_W_up, B_W_down)
    return h2
```

```asm
; @launch grid=(256,1,1) block=(512,1,1) lds=163840
.amdgcn_target "amdgcn-amd-amdhsa--gfx950"
.text
.globl sequential_preLN__ssm_conv_h3__glu_gated_reglu__prompt_kernel
.p2align 8
.type sequential_preLN__ssm_conv_h3__glu_gated_reglu__prompt_kernel,@function
sequential_preLN__ssm_conv_h3__glu_gated_reglu__prompt_kernel:
    s_cmp_ge_u32 s2, 256
    s_cbranch_scc1 K1_END
    s_cmp_ge_u32 s2, 160
    s_cbranch_scc1 K1_PACK
    s_load_dwordx4 s[4:7], s[0:1], 0
    s_load_dwordx4 s[8:11], s[0:1], 16
    s_load_dwordx4 s[16:19], s[0:1], 32
    s_load_dwordx4 s[20:23], s[0:1], 88
    v_lshrrev_b32 v1, 6, v0
    v_and_b32 v2, 63, v0
    v_readfirstlane_b32 s14, v1
    s_lshr_b32 s15, s2, 4
    s_and_b32 s24, s2, 7
    s_lshl_b32 s24, s24, 1
    s_bfe_u32 s25, s2, 0x10003
    s_add_u32 s24, s24, s25
    s_lshl_b32 s3, s15, 4
    s_add_u32 s3, s3, s24
    v_lshlrev_b32 v3, 4, v2
    s_cmp_lg_u32 s14, 0
    s_cbranch_scc1 K01_NOSELF
    s_lshr_b32 s34, s2, 3
    s_cmp_ge_u32 s34, 20
    s_cbranch_scc1 PF_SKIP_SELF
    s_getpc_b64 s[32:33]
PF_PC_SELF:
    s_add_u32 s32, s32, K01_CODE0-PF_PC_SELF
    s_addc_u32 s33, s33, 0
    s_lshl_b32 s34, s34, 10
    v_lshlrev_b32 v29, 4, v2
    v_add_u32 v29, s34, v29
    global_load_dwordx4 v[224:227], v29, s[32:33]
PF_SKIP_SELF:
K01_NOSELF:
K01_CODE0:
    v_lshrrev_b32 v4, 5, v2
    v_and_b32 v5, 31, v2
    s_lshl_b32 s25, s14, 1
    v_add_u32 v4, s25, v4
    s_movk_i32 s25, 10240
    v_mul_u32_u24 v6, s25, v4
    v_lshl_add_u32 v6, v5, 2, v6
    s_mul_i32 s25, s24, 163840
    s_lshl_b32 s26, s15, 7
    s_add_u32 s25, s25, s26
    v_add_u32 v6, s25, v6
    v_add_u32 v7, 5120, v6
    v_subrev_u32 v8, 3840, v6
    v_lshlrev_b32 v9, 4, v5
    s_lshl_b32 s26, s15, 9
    v_add_u32 v9, s26, v9
    s_and_b32 s44, s14, 3
    s_lshr_b32 s45, s14, 2
    s_lshl_b32 s46, s3, 2
    s_add_u32 s46, s46, s44
    s_waitcnt lgkmcnt(0)
    s_mov_b32 s28, s6
    s_mov_b32 s29, s7
    s_mov_b32 s30, 2621440
    s_mov_b32 s31, 0x20000
    global_load_dwordx4 v[32:35], v9, s[10:11]
    buffer_load_dword v10, v8, s[28:31], 0 offen offset:0
    buffer_load_dword v11, v8, s[28:31], 0 offen offset:1280
    buffer_load_dword v12, v8, s[28:31], 0 offen offset:2560
    buffer_load_dword v13, v6, s[28:31], 0 offen offset:0
    buffer_load_dword v14, v6, s[28:31], 0 offen offset:1280
    buffer_load_dword v15, v6, s[28:31], 0 offen offset:2560
    buffer_load_dword v16, v6, s[28:31], 0 offen offset:3840
    buffer_load_dword v17, v7, s[28:31], 0 offen offset:0
    buffer_load_dword v18, v7, s[28:31], 0 offen offset:1280
    buffer_load_dword v19, v7, s[28:31], 0 offen offset:2560
    buffer_load_dword v20, v7, s[28:31], 0 offen offset:3840
    global_load_dword v21, v6, s[8:9] offset:0
    global_load_dword v22, v6, s[8:9] offset:1280
    global_load_dword v23, v6, s[8:9] offset:2560
    global_load_dword v24, v6, s[8:9] offset:3840
    global_load_dword v25, v7, s[8:9] offset:0
    global_load_dword v26, v7, s[8:9] offset:1280
    global_load_dword v27, v7, s[8:9] offset:2560
    global_load_dword v28, v7, s[8:9] offset:3840
    s_mov_b32 s12, s22
    s_mov_b32 s13, s23
    s_mov_b32 s36, s22
    s_mov_b32 s37, s23
    s_mov_b32 s38, 20512768
    s_mov_b32 s39, 0x20000
    s_mov_b32 s40, s20
    s_mov_b32 s41, s21
    s_mov_b32 s42, 256
    s_mov_b32 s43, 0x20000
    s_lshl_b32 s26, s46, 12
    s_add_u32 s50, s16, s26
    s_addc_u32 s51, s17, 0
    s_lshl_b32 s26, s3, 3
    s_load_dwordx2 s[56:57], s[18:19], s26
    s_mul_i32 s47, s44, 8448
    s_mul_i32 s59, s45, 4224
    s_add_u32 s59, s59, s47
    s_mul_i32 s58, s44, 9280
    s_mul_i32 s26, s45, 4640
    s_add_u32 s58, s58, s26
    s_add_u32 s58, s58, 33792
    s_lshl_b32 s26, s15, 8
    s_add_u32 s26, s26, 20504576
    v_mov_b32 v117, s26
    v_mov_b32 v118, 0
    v_mov_b32 v120, 0
    v_mov_b32 v128, 0
    v_mov_b32 v129, 0
    v_mov_b32 v130, 0
    v_mov_b32 v131, 0
    v_mov_b32 v119, 1
    v_add_u32 v132, s59, v3
    s_add_u32 s26, s58, 4032
    v_add_u32 v133, s26, v3
    v_cmp_lt_u32 vcc, 3, v2
    s_mul_i32 s26, s46, 4224
    s_xor_b32 s27, s45, 1
    v_cndmask_b32 v132, v132, v133, vcc
    s_mov_b32 exec_hi, 0
    ds_write_b128 v132, v[128:131]
    s_mov_b64 exec, -1
    s_lshl_b32 s27, s27, 2
    s_add_u32 s26, s26, s27
    s_add_u32 s26, s26, 0
    s_add_u32 s48, s12, s26
    s_addc_u32 s49, s13, 0
    s_movk_i32 s26, 544
    v_mul_u32_u24 v134, s26, v5
    v_lshlrev_b32 v135, 4, v4
    v_sub_u32 v134, v134, v135
    v_add_u32 v134, 71152, v134
    s_cmp_ge_u32 s14, 4
    s_cbranch_scc1 K01_EPI0
    s_waitcnt vmcnt(19)
    v_lshlrev_b32 v40, 16, v32
    v_lshlrev_b32 v41, 16, v34
    v_and_b32 v42, 0xffff0000, v32
    v_and_b32 v43, 0xffff0000, v34
    v_lshlrev_b32 v44, 16, v33
    v_lshlrev_b32 v45, 16, v35
    v_and_b32 v46, 0xffff0000, v33
    v_and_b32 v47, 0xffff0000, v35
    s_waitcnt vmcnt(18)
    v_lshlrev_b32 v50, 16, v10
    v_and_b32 v51, 0xffff0000, v10
    s_waitcnt vmcnt(17)
    v_lshlrev_b32 v52, 16, v11
    v_and_b32 v53, 0xffff0000, v11
    s_waitcnt vmcnt(16)
    v_lshlrev_b32 v54, 16, v12
    v_and_b32 v55, 0xffff0000, v12
    s_waitcnt vmcnt(15)
    v_lshlrev_b32 v56, 16, v13
    v_and_b32 v57, 0xffff0000, v13
    s_waitcnt vmcnt(14)
    v_lshlrev_b32 v58, 16, v14
    v_and_b32 v59, 0xffff0000, v14
    s_waitcnt vmcnt(13)
    v_lshlrev_b32 v60, 16, v15
    v_and_b32 v61, 0xffff0000, v15
    s_waitcnt vmcnt(12)
    v_lshlrev_b32 v62, 16, v16
    v_and_b32 v63, 0xffff0000, v16
    s_waitcnt vmcnt(11)
    v_lshlrev_b32 v64, 16, v17
    v_and_b32 v65, 0xffff0000, v17
    s_waitcnt vmcnt(10)
    v_lshlrev_b32 v66, 16, v18
    v_and_b32 v67, 0xffff0000, v18
    s_waitcnt vmcnt(9)
    v_lshlrev_b32 v68, 16, v19
    v_and_b32 v69, 0xffff0000, v19
    s_waitcnt vmcnt(8)
    v_lshlrev_b32 v70, 16, v20
    v_and_b32 v71, 0xffff0000, v20
    v_pk_mul_f32 v[72:73], v[50:51], v[46:47]
    v_pk_mul_f32 v[74:75], v[52:53], v[46:47]
    v_pk_mul_f32 v[76:77], v[54:55], v[46:47]
    v_pk_mul_f32 v[78:79], v[56:57], v[46:47]
    v_pk_mul_f32 v[80:81], v[58:59], v[46:47]
    v_pk_mul_f32 v[82:83], v[60:61], v[46:47]
    v_pk_mul_f32 v[84:85], v[62:63], v[46:47]
    v_pk_mul_f32 v[86:87], v[64:65], v[46:47]
    v_pk_fma_f32 v[72:73], v[52:53], v[44:45], v[72:73]
    v_pk_fma_f32 v[74:75], v[54:55], v[44:45], v[74:75]
    v_pk_fma_f32 v[76:77], v[56:57], v[44:45], v[76:77]
    v_pk_fma_f32 v[78:79], v[58:59], v[44:45], v[78:79]
    v_pk_fma_f32 v[80:81], v[60:61], v[44:45], v[80:81]
    v_pk_fma_f32 v[82:83], v[62:63], v[44:45], v[82:83]
    v_pk_fma_f32 v[84:85], v[64:65], v[44:45], v[84:85]
    v_pk_fma_f32 v[86:87], v[66:67], v[44:45], v[86:87]
    v_pk_fma_f32 v[72:73], v[54:55], v[42:43], v[72:73]
    v_pk_fma_f32 v[74:75], v[56:57], v[42:43], v[74:75]
    v_pk_fma_f32 v[76:77], v[58:59], v[42:43], v[76:77]
    v_pk_fma_f32 v[78:79], v[60:61], v[42:43], v[78:79]
    v_pk_fma_f32 v[80:81], v[62:63], v[42:43], v[80:81]
    v_pk_fma_f32 v[82:83], v[64:65], v[42:43], v[82:83]
    v_pk_fma_f32 v[84:85], v[66:67], v[42:43], v[84:85]
    v_pk_fma_f32 v[86:87], v[68:69], v[42:43], v[86:87]
    v_pk_fma_f32 v[72:73], v[56:57], v[40:41], v[72:73]
    v_pk_fma_f32 v[74:75], v[58:59], v[40:41], v[74:75]
    v_pk_fma_f32 v[76:77], v[60:61], v[40:41], v[76:77]
    v_pk_fma_f32 v[78:79], v[62:63], v[40:41], v[78:79]
    v_pk_fma_f32 v[80:81], v[64:65], v[40:41], v[80:81]
    v_pk_fma_f32 v[82:83], v[66:67], v[40:41], v[82:83]
    v_pk_fma_f32 v[84:85], v[68:69], v[40:41], v[84:85]
    v_pk_fma_f32 v[86:87], v[70:71], v[40:41], v[86:87]
    s_waitcnt vmcnt(7)
    v_lshlrev_b32 v88, 16, v21
    v_and_b32 v89, 0xffff0000, v21
    s_waitcnt vmcnt(6)
    v_lshlrev_b32 v90, 16, v22
    v_and_b32 v91, 0xffff0000, v22
    s_waitcnt vmcnt(5)
    v_lshlrev_b32 v92, 16, v23
    v_and_b32 v93, 0xffff0000, v23
    s_waitcnt vmcnt(4)
    v_lshlrev_b32 v94, 16, v24
    v_and_b32 v95, 0xffff0000, v24
    s_waitcnt vmcnt(3)
    v_lshlrev_b32 v96, 16, v25
    v_and_b32 v97, 0xffff0000, v25
    s_waitcnt vmcnt(2)
    v_lshlrev_b32 v98, 16, v26
    v_and_b32 v99, 0xffff0000, v26
    s_waitcnt vmcnt(1)
    v_lshlrev_b32 v100, 16, v27
    v_and_b32 v101, 0xffff0000, v27
    s_waitcnt vmcnt(0)
    v_lshlrev_b32 v102, 16, v28
    v_and_b32 v103, 0xffff0000, v28
    v_pk_mul_f32 v[72:73], v[72:73], v[88:89]
    v_pk_mul_f32 v[74:75], v[74:75], v[90:91]
    v_pk_mul_f32 v[76:77], v[76:77], v[92:93]
    v_pk_mul_f32 v[78:79], v[78:79], v[94:95]
    v_pk_mul_f32 v[80:81], v[80:81], v[96:97]
    v_pk_mul_f32 v[82:83], v[82:83], v[98:99]
    v_pk_mul_f32 v[84:85], v[84:85], v[100:101]
    v_pk_mul_f32 v[86:87], v[86:87], v[102:103]
    v_cvt_pk_bf16_f32 v104, v86, v84
    v_cvt_pk_bf16_f32 v105, v82, v80
    v_cvt_pk_bf16_f32 v106, v78, v76
    v_cvt_pk_bf16_f32 v107, v74, v72
    v_cvt_pk_bf16_f32 v108, v87, v85
    v_cvt_pk_bf16_f32 v109, v83, v81
    v_cvt_pk_bf16_f32 v110, v79, v77
    v_cvt_pk_bf16_f32 v111, v75, v73
    ds_write_b128 v134, v[104:107]
    ds_write_b128 v134, v[108:111] offset:272
    v_mov_b32 v31, 103712
    ds_write_b128 v31, v[128:131]
    ds_write_b128 v31, v[128:131] offset:16
    v_and_b32 v4, 15, v2
    v_lshrrev_b32 v5, 4, v2
    v_and_b32 v6, 1, v4
    v_lshrrev_b32 v7, 1, v4
    v_lshlrev_b32 v8, 3, v5
    v_lshl_add_u32 v8, v6, 1, v8
    v_lshl_add_u32 v9, v7, 5, v8
    v_lshrrev_b32 v135, 4, v0
    s_movk_i32 s26, 272
    v_mul_u32_u24 v137, s26, v135
    v_lshl_add_u32 v137, v4, 4, v137
    v_add_u32 v137, 70912, v137
    s_movk_i32 s26, 4224
    v_mul_u32_u24 v138, s26, v135
    v_lshl_add_u32 v138, v4, 4, v138
    s_mul_i32 s26, s15, 270336
    s_lshl_b32 s27, s24, 8
    s_sub_u32 s26, s26, s27
    s_add_u32 s26, s26, 3840
    v_add_u32 v138, s26, v138
    s_mov_b32 s32, 67584
    s_mov_b32 s33, 135168
    s_mov_b32 s34, 202752
    s_waitcnt lgkmcnt(0)
    s_barrier
    ds_read_b128 v[140:143], v137 offset:0
    ds_read_b128 v[144:147], v137 offset:4352
    ds_read_b128 v[148:151], v137 offset:8704
    ds_read_b128 v[152:155], v137 offset:13056
    s_waitcnt lgkmcnt(3)
    buffer_store_dwordx4 v[140:143], v138, s[36:39], 0 offen sc1
    s_waitcnt lgkmcnt(2)
    buffer_store_dwordx4 v[144:147], v138, s[36:39], s32 offen sc1
    s_waitcnt lgkmcnt(1)
    buffer_store_dwordx4 v[148:151], v138, s[36:39], s33 offen sc1
    s_waitcnt lgkmcnt(0)
    buffer_store_dwordx4 v[152:155], v138, s[36:39], s34 offen sc1
    s_cmp_lg_u32 s24, 0
    s_cbranch_scc1 K01_NOL
    v_cmp_eq_u32 vcc, 15, v4
    s_and_saveexec_b64 s[26:27], vcc
    buffer_store_dwordx4 v[128:131], v138, s[36:39], 0 offen offset:16 sc1
    buffer_store_dwordx4 v[128:131], v138, s[36:39], s32 offen offset:16 sc1
    buffer_store_dwordx4 v[128:131], v138, s[36:39], s33 offen offset:16 sc1
    buffer_store_dwordx4 v[128:131], v138, s[36:39], s34 offen offset:16 sc1
    s_mov_b64 exec, -1
K01_NOL:
    s_cmp_lg_u32 s14, 0
    s_cbranch_scc1 K01_NORD
    buffer_load_dword v120, v118, s[40:43], 0 offen sc1
K01_NORD:
    s_waitcnt vmcnt(0)
    v_lshlrev_b32 v120, 8, v120
    v_add_u32 v120, 1, v120
    s_mov_b64 exec, 1
    ds_add_rtn_u32 v121, v31, v120
    s_mov_b64 exec, -1
    s_waitcnt lgkmcnt(0)
    v_add_u32 v121, v121, v120
    s_nop 0
    v_readfirstlane_b32 s26, v121
    s_nop 1
    s_and_b32 s27, s26, 0xff
    s_cmp_lg_u32 s27, 4
    s_cbranch_scc1 K01_WGO
    s_cmp_ge_u32 s26, 256
    s_cbranch_scc1 SPUN_RDY
    s_mov_b32 s35, 400000
SPIN_RDY:
    buffer_load_dword v120, v118, s[40:43], 0 offen sc1
    s_waitcnt vmcnt(0)
    v_cmp_le_u32 vcc, 1, v120
    s_nop 1
    s_cmp_eq_u64 vcc, -1
    s_cbranch_scc1 SPUN_RDY
    s_sleep 1
    s_sub_u32 s35, s35, 1
    s_cmp_lg_u32 s35, 0
    s_cbranch_scc1 SPIN_RDY
SPUN_RDY:
    s_mov_b64 exec, 1
    buffer_atomic_add v119, v117, s[36:39], 0 offen
    s_mov_b64 exec, -1
    s_mov_b32 s35, 400000
SPIN_GRP:
    buffer_load_dword v120, v117, s[36:39], 0 offen sc1
    s_waitcnt vmcnt(0)
    v_cmp_le_u32 vcc, 16, v120
    s_nop 1
    s_cmp_eq_u64 vcc, -1
    s_cbranch_scc1 SPUN_GRP
    s_sleep 1
    s_sub_u32 s35, s35, 1
    s_cmp_lg_u32 s35, 0
    s_cbranch_scc1 SPIN_GRP
SPUN_GRP:
    ds_write_b32 v31, v119 offset:4
    s_branch K01_GO
K01_WGO:
    s_mov_b32 s35, 8000000
LW_GO:
    ds_read_b32 v30, v31 offset:4
    s_waitcnt lgkmcnt(0)
    v_readfirstlane_b32 s26, v30
    s_nop 1
    s_cmp_ge_u32 s26, 1
    s_cbranch_scc1 LD_GO
    s_sleep 1
    s_sub_u32 s35, s35, 1
    s_cmp_lg_u32 s35, 0
    s_cbranch_scc1 LW_GO
LD_GO:
K01_GO:
    s_add_u32 m0, s58, 4640
    s_sub_u32 s52, s48, 4
    s_subb_u32 s53, s49, 0
    global_load_lds_dwordx4 v3, s[52:53] offset:0
    global_load_lds_dwordx4 v3, s[52:53] offset:1024
    global_load_lds_dwordx4 v3, s[52:53] offset:2048
    global_load_lds_dwordx4 v3, s[52:53] offset:3072
    s_mov_b32 m0, s58
    s_nop 0
    global_load_lds_dwordx4 v3, s[48:49] offset:0
    global_load_lds_dwordx4 v3, s[48:49] offset:1024
    global_load_lds_dwordx4 v3, s[48:49] offset:2048
    global_load_lds_dwordx4 v3, s[48:49] offset:3072
    s_movk_i32 s26, 4224
    v_mul_u32_u24 v20, s26, v6
    v_lshl_add_u32 v20, v7, 3, v20
    v_lshl_add_u32 v20, v5, 4, v20
    s_add_u32 s27, s47, 8
    v_add_u32 v20, s27, v20
    s_movk_i32 s26, 4640
    v_mul_u32_u24 v21, s26, v6
    v_lshlrev_b32 v22, 6, v7
    v_sub_u32 v21, v21, v22
    v_lshl_add_u32 v21, v5, 4, v21
    s_add_u32 s27, s58, 448
    v_add_u32 v21, s27, v21
    s_lshl_b32 s26, s14, 13
    s_add_u32 s26, s26, 70912
    v_add_u32 v23, s26, v3
    s_mov_b32 s35, 8000000
LW_TAP:
    ds_read_b32 v30, v31 offset:20
    s_waitcnt lgkmcnt(0)
    v_readfirstlane_b32 s26, v30
    s_nop 1
    s_cmp_ge_u32 s26, 4
    s_cbranch_scc1 LD_TAP
    s_sleep 1
    s_sub_u32 s35, s35, 1
    s_cmp_lg_u32 s35, 0
    s_cbranch_scc1 LW_TAP
LD_TAP:
    ds_read_b64 v[64:65], v20 offset:0
    ds_read_b64 v[66:67], v20 offset:8
    ds_read_b64 v[68:69], v20 offset:512
    ds_read_b64 v[70:71], v20 offset:520
    ds_read_b64 v[72:73], v20 offset:1024
    ds_read_b64 v[74:75], v20 offset:1032
    ds_read_b64 v[76:77], v20 offset:1536
    ds_read_b64 v[78:79], v20 offset:1544
    ds_read_b64 v[80:81], v20 offset:2048
    ds_read_b64 v[82:83], v20 offset:2056
    ds_read_b64 v[84:85], v20 offset:2560
    ds_read_b64 v[86:87], v20 offset:2568
    ds_read_b64 v[88:89], v20 offset:3072
    ds_read_b64 v[90:91], v20 offset:3080
    ds_read_b64 v[92:93], v20 offset:3584
    ds_read_b64 v[94:95], v20 offset:3592
    s_waitcnt vmcnt(0) lgkmcnt(0)
    s_mov_b64 exec, 1
    ds_add_u32 v31, v119 offset:16
    s_mov_b64 exec, -1
    ds_read_b128 v[96:99], v21 offset:3584
    ds_read_b128 v[100:103], v21 offset:3072
    ds_read_b128 v[104:107], v21 offset:2560
    ds_read_b128 v[108:111], v21 offset:2048
    ds_read_b128 v[112:115], v21 offset:1536
    ds_read_b128 v[116:119], v21 offset:1024
    ds_read_b128 v[120:123], v21 offset:512
    ds_read_b128 v[124:127], v21 offset:0
    s_waitcnt lgkmcnt(7)
    v_mfma_f32_16x16x32_bf16 v[32:35], v[64:67], v[96:99], 0
    v_mfma_f32_16x16x32_bf16 v[36:39], v[68:71], v[96:99], 0
    v_mfma_f32_16x16x32_bf16 v[40:43], v[72:75], v[96:99], 0
    v_mfma_f32_16x16x32_bf16 v[44:47], v[76:79], v[96:99], 0
    v_mfma_f32_16x16x32_bf16 v[48:51], v[80:83], v[96:99], 0
    v_mfma_f32_16x16x32_bf16 v[52:55], v[84:87], v[96:99], 0
    v_mfma_f32_16x16x32_bf16 v[56:59], v[88:91], v[96:99], 0
    v_mfma_f32_16x16x32_bf16 v[60:63], v[92:95], v[96:99], 0
    s_waitcnt lgkmcnt(6)
    v_mfma_f32_16x16x32_bf16 v[36:39], v[64:67], v[100:103], v[36:39]
    ds_read_b64 v[128:129], v20 offset:64
    v_mfma_f32_16x16x32_bf16 v[40:43], v[68:71], v[100:103], v[40:43]
    ds_read_b64 v[130:131], v20 offset:72
    v_mfma_f32_16x16x32_bf16 v[44:47], v[72:75], v[100:103], v[44:47]
    ds_read_b128 v[160:163], v21 offset:3648
    v_mfma_f32_16x16x32_bf16 v[48:51], v[76:79], v[100:103], v[48:51]
    ds_read_b64 v[132:133], v20 offset:576
    v_mfma_f32_16x16x32_bf16 v[52:55], v[80:83], v[100:103], v[52:55]
    ds_read_b64 v[134:135], v20 offset:584
    v_mfma_f32_16x16x32_bf16 v[56:59], v[84:87], v[100:103], v[56:59]
    ds_read_b128 v[164:167], v21 offset:3136
    v_mfma_f32_16x16x32_bf16 v[60:63], v[88:91], v[100:103], v[60:63]
    ds_read_b64 v[136:137], v20 offset:1088
    s_waitcnt lgkmcnt(12)
    v_mfma_f32_16x16x32_bf16 v[40:43], v[64:67], v[104:107], v[40:43]
    ds_read_b64 v[138:139], v20 offset:1096
    v_mfma_f32_16x16x32_bf16 v[44:47], v[68:71], v[104:107], v[44:47]
    ds_read_b128 v[168:171], v21 offset:2624
    v_mfma_f32_16x16x32_bf16 v[48:51], v[72:75], v[104:107], v[48:51]
    ds_read_b64 v[140:141], v20 offset:1600
    v_mfma_f32_16x16x32_bf16 v[52:55], v[76:79], v[104:107], v[52:55]
    ds_read_b64 v[142:143], v20 offset:1608
    v_mfma_f32_16x16x32_bf16 v[56:59], v[80:83], v[104:107], v[56:59]
    ds_read_b128 v[172:175], v21 offset:2112
    v_mfma_f32_16x16x32_bf16 v[60:63], v[84:87], v[104:107], v[60:63]
    ds_read_b64 v[144:145], v20 offset:2112
    s_waitcnt lgkmcnt(15)
    v_mfma_f32_16x16x32_bf16 v[44:47], v[64:67], v[108:111], v[44:47]
    ds_read_b64 v[146:147], v20 offset:2120
    v_mfma_f32_16x16x32_bf16 v[48:51], v[68:71], v[108:111], v[48:51]
    ds_read_b128 v[176:179], v21 offset:1600
    v_mfma_f32_16x16x32_bf16 v[52:55], v[72:75], v[108:111], v[52:55]
    ds_read_b64 v[148:149], v20 offset:2624
    v_mfma_f32_16x16x32_bf16 v[56:59], v[76:79], v[108:111], v[56:59]
    ds_read_b64 v[150:151], v20 offset:2632
    v_mfma_f32_16x16x32_bf16 v[60:63], v[80:83], v[108:111], v[60:63]
    ds_read_b128 v[180:183], v21 offset:1088
    s_waitcnt lgkmcnt(15)
    v_mfma_f32_16x16x32_bf16 v[48:51], v[64:67], v[112:115], v[48:51]
    ds_read_b64 v[152:153], v20 offset:3136
    v_mfma_f32_16x16x32_bf16 v[52:55], v[68:71], v[112:115], v[52:55]
    ds_read_b64 v[154:155], v20 offset:3144
    v_mfma_f32_16x16x32_bf16 v[56:59], v[72:75], v[112:115], v[56:59]
    ds_read_b128 v[184:187], v21 offset:576
    v_mfma_f32_16x16x32_bf16 v[60:63], v[76:79], v[112:115], v[60:63]
    ds_read_b64 v[156:157], v20 offset:3648
    s_waitcnt lgkmcnt(15)
    v_mfma_f32_16x16x32_bf16 v[52:55], v[64:67], v[116:119], v[52:55]
    ds_read_b64 v[158:159], v20 offset:3656
    v_mfma_f32_16x16x32_bf16 v[56:59], v[68:71], v[116:119], v[56:59]
    ds_read_b128 v[188:191], v21 offset:64
    v_mfma_f32_16x16x32_bf16 v[60:63], v[72:75], v[116:119], v[60:63]
    s_waitcnt lgkmcnt(15)
    v_mfma_f32_16x16x32_bf16 v[56:59], v[64:67], v[120:123], v[56:59]
    v_mfma_f32_16x16x32_bf16 v[60:63], v[68:71], v[120:123], v[60:63]
    s_waitcnt lgkmcnt(15)
    v_mfma_f32_16x16x32_bf16 v[60:63], v[64:67], v[124:127], v[60:63]
    s_waitcnt lgkmcnt(0)
    v_mfma_f32_16x16x32_bf16 v[32:35], v[128:131], v[160:163], v[32:35]
    ds_read_b64 v[64:65], v20 offset:128
    v_mfma_f32_16x16x32_bf16 v[36:39], v[128:131], v[164:167], v[36:39]
    ds_read_b64 v[66:67], v20 offset:136
    v_mfma_f32_16x16x32_bf16 v[36:39], v[132:135], v[160:163], v[36:39]
    ds_read_b128 v[96:99], v21 offset:3712
    v_mfma_f32_16x16x32_bf16 v[40:43], v[128:131], v[168:171], v[40:43]
    ds_read_b64 v[68:69], v20 offset:640
    v_mfma_f32_16x16x32_bf16 v[40:43], v[132:135], v[164:167], v[40:43]
    ds_read_b64 v[70:71], v20 offset:648
    v_mfma_f32_16x16x32_bf16 v[40:43], v[136:139], v[160:163], v[40:43]
    ds_read_b128 v[100:103], v21 offset:3200
    v_mfma_f32_16x16x32_bf16 v[44:47], v[128:131], v[172:175], v[44:47]
    ds_read_b64 v[72:73], v20 offset:1152
    v_mfma_f32_16x16x32_bf16 v[44:47], v[132:135], v[168:171], v[44:47]
    ds_read_b64 v[74:75], v20 offset:1160
    v_mfma_f32_16x16x32_bf16 v[44:47], v[136:139], v[164:167], v[44:47]
    ds_read_b128 v[104:107], v21 offset:2688
    v_mfma_f32_16x16x32_bf16 v[44:47], v[140:143], v[160:163], v[44:47]
    ds_read_b64 v[76:77], v20 offset:1664
    v_mfma_f32_16x16x32_bf16 v[48:51], v[128:131], v[176:179], v[48:51]
    ds_read_b64 v[78:79], v20 offset:1672
    v_mfma_f32_16x16x32_bf16 v[48:51], v[132:135], v[172:175], v[48:51]
    ds_read_b128 v[108:111], v21 offset:2176
    v_mfma_f32_16x16x32_bf16 v[48:51], v[136:139], v[168:171], v[48:51]
    ds_read_b64 v[80:81], v20 offset:2176
    v_mfma_f32_16x16x32_bf16 v[48:51], v[140:143], v[164:167], v[48:51]
    ds_read_b64 v[82:83], v20 offset:2184
    v_mfma_f32_16x16x32_bf16 v[48:51], v[144:147], v[160:163], v[48:51]
    ds_read_b128 v[112:115], v21 offset:1664
    v_mfma_f32_16x16x32_bf16 v[52:55], v[128:131], v[180:183], v[52:55]
    ds_read_b64 v[84:85], v20 offset:2688
    v_mfma_f32_16x16x32_bf16 v[52:55], v[132:135], v[176:179], v[52:55]
    ds_read_b64 v[86:87], v20 offset:2696
    v_mfma_f32_16x16x32_bf16 v[52:55], v[136:139], v[172:175], v[52:55]
    ds_read_b128 v[116:119], v21 offset:1152
    v_mfma_f32_16x16x32_bf16 v[52:55], v[140:143], v[168:171], v[52:55]
    ds_read_b64 v[88:89], v20 offset:3200
    v_mfma_f32_16x16x32_bf16 v[52:55], v[144:147], v[164:167], v[52:55]
    ds_read_b64 v[90:91], v20 offset:3208
    v_mfma_f32_16x16x32_bf16 v[52:55], v[148:151], v[160:163], v[52:55]
    ds_read_b128 v[120:123], v21 offset:640
    v_mfma_f32_16x16x32_bf16 v[56:59], v[128:131], v[184:187], v[56:59]
    ds_read_b64 v[92:93], v20 offset:3712
    v_mfma_f32_16x16x32_bf16 v[56:59], v[132:135], v[180:183], v[56:59]
    ds_read_b64 v[94:95], v20 offset:3720
    v_mfma_f32_16x16x32_bf16 v[56:59], v[136:139], v[176:179], v[56:59]
    ds_read_b128 v[124:127], v21 offset:128
    v_mfma_f32_16x16x32_bf16 v[56:59], v[140:143], v[172:175], v[56:59]
    v_mfma_f32_16x16x32_bf16 v[56:59], v[144:147], v[168:171], v[56:59]
    v_mfma_f32_16x16x32_bf16 v[56:59], v[148:151], v[164:167], v[56:59]
    v_mfma_f32_16x16x32_bf16 v[56:59], v[152:155], v[160:163], v[56:59]
    v_mfma_f32_16x16x32_bf16 v[60:63], v[128:131], v[188:191], v[60:63]
    v_mfma_f32_16x16x32_bf16 v[60:63], v[132:135], v[184:187], v[60:63]
    v_mfma_f32_16x16x32_bf16 v[60:63], v[136:139], v[180:183], v[60:63]
    v_mfma_f32_16x16x32_bf16 v[60:63], v[140:143], v[176:179], v[60:63]
    v_mfma_f32_16x16x32_bf16 v[60:63], v[144:147], v[172:175], v[60:63]
    v_mfma_f32_16x16x32_bf16 v[60:63], v[148:151], v[168:171], v[60:63]
    v_mfma_f32_16x16x32_bf16 v[60:63], v[152:155], v[164:167], v[60:63]
    v_mfma_f32_16x16x32_bf16 v[60:63], v[156:159], v[160:163], v[60:63]
    s_waitcnt lgkmcnt(0)
    v_mfma_f32_16x16x32_bf16 v[32:35], v[64:67], v[96:99], v[32:35]
    ds_read_b64 v[128:129], v20 offset:192
    v_mfma_f32_16x16x32_bf16 v[36:39], v[64:67], v[100:103], v[36:39]
    ds_read_b64 v[130:131], v20 offset:200
    v_mfma_f32_16x16x32_bf16 v[36:39], v[68:71], v[96:99], v[36:39]
    ds_read_b128 v[160:163], v21 offset:3776
    v_mfma_f32_16x16x32_bf16 v[40:43], v[64:67], v[104:107], v[40:43]
    ds_read_b64 v[132:133], v20 offset:704
    v_mfma_f32_16x16x32_bf16 v[40:43], v[68:71], v[100:103], v[40:43]
    ds_read_b64 v[134:135], v20 offset:712
    v_mfma_f32_16x16x32_bf16 v[40:43], v[72:75], v[96:99], v[40:43]
    ds_read_b128 v[164:167], v21 offset:3264
    v_mfma_f32_16x16x32_bf16 v[44:47], v[64:67], v[108:111], v[44:47]
    ds_read_b64 v[136:137], v20 offset:1216
    v_mfma_f32_16x16x32_bf16 v[44:47], v[68:71], v[104:107], v[44:47]
    ds_read_b64 v[138:139], v20 offset:1224
    v_mfma_f32_16x16x32_bf16 v[44:47], v[72:75], v[100:103], v[44:47]
    ds_read_b128 v[168:171], v21 offset:2752
    v_mfma_f32_16x16x32_bf16 v[44:47], v[76:79], v[96:99], v[44:47]
    ds_read_b64 v[140:141], v20 offset:1728
    v_mfma_f32_16x16x32_bf16 v[48:51], v[64:67], v[112:115], v[48:51]
    ds_read_b64 v[142:143], v20 offset:1736
    v_mfma_f32_16x16x32_bf16 v[48:51], v[68:71], v[108:111], v[48:51]
    ds_read_b128 v[172:175], v21 offset:2240
    v_mfma_f32_16x16x32_bf16 v[48:51], v[72:75], v[104:107], v[48:51]
    ds_read_b64 v[144:145], v20 offset:2240
    v_mfma_f32_16x16x32_bf16 v[48:51], v[76:79], v[100:103], v[48:51]
    ds_read_b64 v[146:147], v20 offset:2248
    v_mfma_f32_16x16x32_bf16 v[48:51], v[80:83], v[96:99], v[48:51]
    ds_read_b128 v[176:179], v21 offset:1728
    v_mfma_f32_16x16x32_bf16 v[52:55], v[64:67], v[116:119], v[52:55]
    ds_read_b64 v[148:149], v20 offset:2752
    v_mfma_f32_16x16x32_bf16 v[52:55], v[68:71], v[112:115], v[52:55]
    ds_read_b64 v[150:151], v20 offset:2760
    v_mfma_f32_16x16x32_bf16 v[52:55], v[72:75], v[108:111], v[52:55]
    ds_read_b128 v[180:183], v21 offset:1216
    v_mfma_f32_16x16x32_bf16 v[52:55], v[76:79], v[104:107], v[52:55]
    ds_read_b64 v[152:153], v20 offset:3264
    v_mfma_f32_16x16x32_bf16 v[52:55], v[80:83], v[100:103], v[52:55]
    ds_read_b64 v[154:155], v20 offset:3272
    v_mfma_f32_16x16x32_bf16 v[52:55], v[84:87], v[96:99], v[52:55]
    ds_read_b128 v[184:187], v21 offset:704
    v_mfma_f32_16x16x32_bf16 v[56:59], v[64:67], v[120:123], v[56:59]
    ds_read_b64 v[156:157], v20 offset:3776
    v_mfma_f32_16x16x32_bf16 v[56:59], v[68:71], v[116:119], v[56:59]
    ds_read_b64 v[158:159], v20 offset:3784
    v_mfma_f32_16x16x32_bf16 v[56:59], v[72:75], v[112:115], v[56:59]
    ds_read_b128 v[188:191], v21 offset:192
    v_mfma_f32_16x16x32_bf16 v[56:59], v[76:79], v[108:111], v[56:59]
    v_mfma_f32_16x16x32_bf16 v[56:59], v[80:83], v[104:107], v[56:59]
    v_mfma_f32_16x16x32_bf16 v[56:59], v[84:87], v[100:103], v[56:59]
    v_mfma_f32_16x16x32_bf16 v[56:59], v[88:91], v[96:99], v[56:59]
    v_mfma_f32_16x16x32_bf16 v[60:63], v[64:67], v[124:127], v[60:63]
    v_mfma_f32_16x16x32_bf16 v[60:63], v[68:71], v[120:123], v[60:63]
    v_mfma_f32_16x16x32_bf16 v[60:63], v[72:75], v[116:119], v[60:63]
    v_mfma_f32_16x16x32_bf16 v[60:63], v[76:79], v[112:115], v[60:63]
    v_mfma_f32_16x16x32_bf16 v[60:63], v[80:83], v[108:111], v[60:63]
    v_mfma_f32_16x16x32_bf16 v[60:63], v[84:87], v[104:107], v[60:63]
    v_mfma_f32_16x16x32_bf16 v[60:63], v[88:91], v[100:103], v[60:63]
    v_mfma_f32_16x16x32_bf16 v[60:63], v[92:95], v[96:99], v[60:63]
    s_waitcnt lgkmcnt(0)
    v_mfma_f32_16x16x32_bf16 v[32:35], v[128:131], v[160:163], v[32:35]
    ds_read_b64 v[64:65], v20 offset:256
    v_mfma_f32_16x16x32_bf16 v[36:39], v[128:131], v[164:167], v[36:39]
    ds_read_b64 v[66:67], v20 offset:264
    v_mfma_f32_16x16x32_bf16 v[36:39], v[132:135], v[160:163], v[36:39]
    ds_read_b128 v[96:99], v21 offset:3840
    v_mfma_f32_16x16x32_bf16 v[40:43], v[128:131], v[168:171], v[40:43]
    ds_read_b64 v[68:69], v20 offset:768
    v_mfma_f32_16x16x32_bf16 v[40:43], v[132:135], v[164:167], v[40:43]
    ds_read_b64 v[70:71], v20 offset:776
    v_mfma_f32_16x16x32_bf16 v[40:43], v[136:139], v[160:163], v[40:43]
    ds_read_b128 v[100:103], v21 offset:3328
    v_mfma_f32_16x16x32_bf16 v[44:47], v[128:131], v[172:175], v[44:47]
    ds_read_b64 v[72:73], v20 offset:1280
    v_mfma_f32_16x16x32_bf16 v[44:47], v[132:135], v[168:171], v[44:47]
    ds_read_b64 v[74:75], v20 offset:1288
    v_mfma_f32_16x16x32_bf16 v[44:47], v[136:139], v[164:167], v[44:47]
    ds_read_b128 v[104:107], v21 offset:2816
    v_mfma_f32_16x16x32_bf16 v[44:47], v[140:143], v[160:163], v[44:47]
    ds_read_b64 v[76:77], v20 offset:1792
    v_mfma_f32_16x16x32_bf16 v[48:51], v[128:131], v[176:179], v[48:51]
    ds_read_b64 v[78:79], v20 offset:1800
    v_mfma_f32_16x16x32_bf16 v[48:51], v[132:135], v[172:175], v[48:51]
    ds_read_b128 v[108:111], v21 offset:2304
    v_mfma_f32_16x16x32_bf16 v[48:51], v[136:139], v[168:171], v[48:51]
    ds_read_b64 v[80:81], v20 offset:2304
    v_mfma_f32_16x16x32_bf16 v[48:51], v[140:143], v[164:167], v[48:51]
    ds_read_b64 v[82:83], v20 offset:2312
    v_mfma_f32_16x16x32_bf16 v[48:51], v[144:147], v[160:163], v[48:51]
    ds_read_b128 v[112:115], v21 offset:1792
    v_mfma_f32_16x16x32_bf16 v[52:55], v[128:131], v[180:183], v[52:55]
    ds_read_b64 v[84:85], v20 offset:2816
    v_mfma_f32_16x16x32_bf16 v[52:55], v[132:135], v[176:179], v[52:55]
    ds_read_b64 v[86:87], v20 offset:2824
    v_mfma_f32_16x16x32_bf16 v[52:55], v[136:139], v[172:175], v[52:55]
    ds_read_b128 v[116:119], v21 offset:1280
    v_mfma_f32_16x16x32_bf16 v[52:55], v[140:143], v[168:171], v[52:55]
    ds_read_b64 v[88:89], v20 offset:3328
    v_mfma_f32_16x16x32_bf16 v[52:55], v[144:147], v[164:167], v[52:55]
    ds_read_b64 v[90:91], v20 offset:3336
    v_mfma_f32_16x16x32_bf16 v[52:55], v[148:151], v[160:163], v[52:55]
    ds_read_b128 v[120:123], v21 offset:768
    v_mfma_f32_16x16x32_bf16 v[56:59], v[128:131], v[184:187], v[56:59]
    ds_read_b64 v[92:93], v20 offset:3840
    v_mfma_f32_16x16x32_bf16 v[56:59], v[132:135], v[180:183], v[56:59]
    ds_read_b64 v[94:95], v20 offset:3848
    v_mfma_f32_16x16x32_bf16 v[56:59], v[136:139], v[176:179], v[56:59]
    ds_read_b128 v[124:127], v21 offset:256
    v_mfma_f32_16x16x32_bf16 v[56:59], v[140:143], v[172:175], v[56:59]
    v_mfma_f32_16x16x32_bf16 v[56:59], v[144:147], v[168:171], v[56:59]
    v_mfma_f32_16x16x32_bf16 v[56:59], v[148:151], v[164:167], v[56:59]
    v_mfma_f32_16x16x32_bf16 v[56:59], v[152:155], v[160:163], v[56:59]
    v_mfma_f32_16x16x32_bf16 v[60:63], v[128:131], v[188:191], v[60:63]
    v_mfma_f32_16x16x32_bf16 v[60:63], v[132:135], v[184:187], v[60:63]
    v_mfma_f32_16x16x32_bf16 v[60:63], v[136:139], v[180:183], v[60:63]
    v_mfma_f32_16x16x32_bf16 v[60:63], v[140:143], v[176:179], v[60:63]
    v_mfma_f32_16x16x32_bf16 v[60:63], v[144:147], v[172:175], v[60:63]
    v_mfma_f32_16x16x32_bf16 v[60:63], v[148:151], v[168:171], v[60:63]
    v_mfma_f32_16x16x32_bf16 v[60:63], v[152:155], v[164:167], v[60:63]
    v_mfma_f32_16x16x32_bf16 v[60:63], v[156:159], v[160:163], v[60:63]
    s_waitcnt lgkmcnt(0)
    v_mfma_f32_16x16x32_bf16 v[32:35], v[64:67], v[96:99], v[32:35]
    ds_read_b64 v[128:129], v20 offset:320
    v_mfma_f32_16x16x32_bf16 v[36:39], v[64:67], v[100:103], v[36:39]
    ds_read_b64 v[130:131], v20 offset:328
    v_mfma_f32_16x16x32_bf16 v[36:39], v[68:71], v[96:99], v[36:39]
    ds_read_b128 v[160:163], v21 offset:3904
    v_mfma_f32_16x16x32_bf16 v[40:43], v[64:67], v[104:107], v[40:43]
    ds_read_b64 v[132:133], v20 offset:832
    v_mfma_f32_16x16x32_bf16 v[40:43], v[68:71], v[100:103], v[40:43]
    ds_read_b64 v[134:135], v20 offset:840
    v_mfma_f32_16x16x32_bf16 v[40:43], v[72:75], v[96:99], v[40:43]
    ds_read_b128 v[164:167], v21 offset:3392
    v_mfma_f32_16x16x32_bf16 v[44:47], v[64:67], v[108:111], v[44:47]
    ds_read_b64 v[136:137], v20 offset:1344
    v_mfma_f32_16x16x32_bf16 v[44:47], v[68:71], v[104:107], v[44:47]
    ds_read_b64 v[138:139], v20 offset:1352
    v_mfma_f32_16x16x32_bf16 v[44:47], v[72:75], v[100:103], v[44:47]
    ds_read_b128 v[168:171], v21 offset:2880
    v_mfma_f32_16x16x32_bf16 v[44:47], v[76:79], v[96:99], v[44:47]
    ds_read_b64 v[140:141], v20 offset:1856
    v_mfma_f32_16x16x32_bf16 v[48:51], v[64:67], v[112:115], v[48:51]
    ds_read_b64 v[142:143], v20 offset:1864
    v_mfma_f32_16x16x32_bf16 v[48:51], v[68:71], v[108:111], v[48:51]
    ds_read_b128 v[172:175], v21 offset:2368
    v_mfma_f32_16x16x32_bf16 v[48:51], v[72:75], v[104:107], v[48:51]
    ds_read_b64 v[144:145], v20 offset:2368
    v_mfma_f32_16x16x32_bf16 v[48:51], v[76:79], v[100:103], v[48:51]
    ds_read_b64 v[146:147], v20 offset:2376
    v_mfma_f32_16x16x32_bf16 v[48:51], v[80:83], v[96:99], v[48:51]
    ds_read_b128 v[176:179], v21 offset:1856
    v_mfma_f32_16x16x32_bf16 v[52:55], v[64:67], v[116:119], v[52:55]
    ds_read_b64 v[148:149], v20 offset:2880
    v_mfma_f32_16x16x32_bf16 v[52:55], v[68:71], v[112:115], v[52:55]
    ds_read_b64 v[150:151], v20 offset:2888
    v_mfma_f32_16x16x32_bf16 v[52:55], v[72:75], v[108:111], v[52:55]
    ds_read_b128 v[180:183], v21 offset:1344
    v_mfma_f32_16x16x32_bf16 v[52:55], v[76:79], v[104:107], v[52:55]
    ds_read_b64 v[152:153], v20 offset:3392
    v_mfma_f32_16x16x32_bf16 v[52:55], v[80:83], v[100:103], v[52:55]
    ds_read_b64 v[154:155], v20 offset:3400
    v_mfma_f32_16x16x32_bf16 v[52:55], v[84:87], v[96:99], v[52:55]
    ds_read_b128 v[184:187], v21 offset:832
    v_mfma_f32_16x16x32_bf16 v[56:59], v[64:67], v[120:123], v[56:59]
    ds_read_b64 v[156:157], v20 offset:3904
    v_mfma_f32_16x16x32_bf16 v[56:59], v[68:71], v[116:119], v[56:59]
    ds_read_b64 v[158:159], v20 offset:3912
    v_mfma_f32_16x16x32_bf16 v[56:59], v[72:75], v[112:115], v[56:59]
    ds_read_b128 v[188:191], v21 offset:320
    v_mfma_f32_16x16x32_bf16 v[56:59], v[76:79], v[108:111], v[56:59]
    v_mfma_f32_16x16x32_bf16 v[56:59], v[80:83], v[104:107], v[56:59]
    v_mfma_f32_16x16x32_bf16 v[56:59], v[84:87], v[100:103], v[56:59]
    v_mfma_f32_16x16x32_bf16 v[56:59], v[88:91], v[96:99], v[56:59]
    v_mfma_f32_16x16x32_bf16 v[60:63], v[64:67], v[124:127], v[60:63]
    v_mfma_f32_16x16x32_bf16 v[60:63], v[68:71], v[120:123], v[60:63]
    v_mfma_f32_16x16x32_bf16 v[60:63], v[72:75], v[116:119], v[60:63]
    v_mfma_f32_16x16x32_bf16 v[60:63], v[76:79], v[112:115], v[60:63]
    v_mfma_f32_16x16x32_bf16 v[60:63], v[80:83], v[108:111], v[60:63]
    v_mfma_f32_16x16x32_bf16 v[60:63], v[84:87], v[104:107], v[60:63]
    v_mfma_f32_16x16x32_bf16 v[60:63], v[88:91], v[100:103], v[60:63]
    v_mfma_f32_16x16x32_bf16 v[60:63], v[92:95], v[96:99], v[60:63]
    s_waitcnt lgkmcnt(0)
    v_mfma_f32_16x16x32_bf16 v[32:35], v[128:131], v[160:163], v[32:35]
    ds_read_b64 v[64:65], v20 offset:384
    v_mfma_f32_16x16x32_bf16 v[36:39], v[128:131], v[164:167], v[36:39]
    ds_read_b64 v[66:67], v20 offset:392
    v_mfma_f32_16x16x32_bf16 v[36:39], v[132:135], v[160:163], v[36:39]
    ds_read_b128 v[96:99], v21 offset:3968
    v_mfma_f32_16x16x32_bf16 v[40:43], v[128:131], v[168:171], v[40:43]
    ds_read_b64 v[68:69], v20 offset:896
    v_mfma_f32_16x16x32_bf16 v[40:43], v[132:135], v[164:167], v[40:43]
    ds_read_b64 v[70:71], v20 offset:904
    v_mfma_f32_16x16x32_bf16 v[40:43], v[136:139], v[160:163], v[40:43]
    ds_read_b128 v[100:103], v21 offset:3456
    v_mfma_f32_16x16x32_bf16 v[44:47], v[128:131], v[172:175], v[44:47]
    ds_read_b64 v[72:73], v20 offset:1408
    v_mfma_f32_16x16x32_bf16 v[44:47], v[132:135], v[168:171], v[44:47]
    ds_read_b64 v[74:75], v20 offset:1416
    v_mfma_f32_16x16x32_bf16 v[44:47], v[136:139], v[164:167], v[44:47]
    ds_read_b128 v[104:107], v21 offset:2944
    v_mfma_f32_16x16x32_bf16 v[44:47], v[140:143], v[160:163], v[44:47]
    ds_read_b64 v[76:77], v20 offset:1920
    v_mfma_f32_16x16x32_bf16 v[48:51], v[128:131], v[176:179], v[48:51]
    ds_read_b64 v[78:79], v20 offset:1928
    v_mfma_f32_16x16x32_bf16 v[48:51], v[132:135], v[172:175], v[48:51]
    ds_read_b128 v[108:111], v21 offset:2432
    v_mfma_f32_16x16x32_bf16 v[48:51], v[136:139], v[168:171], v[48:51]
    ds_read_b64 v[80:81], v20 offset:2432
    v_mfma_f32_16x16x32_bf16 v[48:51], v[140:143], v[164:167], v[48:51]
    ds_read_b64 v[82:83], v20 offset:2440
    v_mfma_f32_16x16x32_bf16 v[48:51], v[144:147], v[160:163], v[48:51]
    ds_read_b128 v[112:115], v21 offset:1920
    v_mfma_f32_16x16x32_bf16 v[52:55], v[128:131], v[180:183], v[52:55]
    ds_read_b64 v[84:85], v20 offset:2944
    v_mfma_f32_16x16x32_bf16 v[52:55], v[132:135], v[176:179], v[52:55]
    ds_read_b64 v[86:87], v20 offset:2952
    v_mfma_f32_16x16x32_bf16 v[52:55], v[136:139], v[172:175], v[52:55]
    ds_read_b128 v[116:119], v21 offset:1408
    v_mfma_f32_16x16x32_bf16 v[52:55], v[140:143], v[168:171], v[52:55]
    ds_read_b64 v[88:89], v20 offset:3456
    v_mfma_f32_16x16x32_bf16 v[52:55], v[144:147], v[164:167], v[52:55]
    ds_read_b64 v[90:91], v20 offset:3464
    v_mfma_f32_16x16x32_bf16 v[52:55], v[148:151], v[160:163], v[52:55]
    ds_read_b128 v[120:123], v21 offset:896
    v_mfma_f32_16x16x32_bf16 v[56:59], v[128:131], v[184:187], v[56:59]
    ds_read_b64 v[92:93], v20 offset:3968
    v_mfma_f32_16x16x32_bf16 v[56:59], v[132:135], v[180:183], v[56:59]
    ds_read_b64 v[94:95], v20 offset:3976
    v_mfma_f32_16x16x32_bf16 v[56:59], v[136:139], v[176:179], v[56:59]
    ds_read_b128 v[124:127], v21 offset:384
    v_mfma_f32_16x16x32_bf16 v[56:59], v[140:143], v[172:175], v[56:59]
    v_mfma_f32_16x16x32_bf16 v[56:59], v[144:147], v[168:171], v[56:59]
    v_mfma_f32_16x16x32_bf16 v[56:59], v[148:151], v[164:167], v[56:59]
    v_mfma_f32_16x16x32_bf16 v[56:59], v[152:155], v[160:163], v[56:59]
    v_mfma_f32_16x16x32_bf16 v[60:63], v[128:131], v[188:191], v[60:63]
    v_mfma_f32_16x16x32_bf16 v[60:63], v[132:135], v[184:187], v[60:63]
    v_mfma_f32_16x16x32_bf16 v[60:63], v[136:139], v[180:183], v[60:63]
    v_mfma_f32_16x16x32_bf16 v[60:63], v[140:143], v[176:179], v[60:63]
    v_mfma_f32_16x16x32_bf16 v[60:63], v[144:147], v[172:175], v[60:63]
    v_mfma_f32_16x16x32_bf16 v[60:63], v[148:151], v[168:171], v[60:63]
    v_mfma_f32_16x16x32_bf16 v[60:63], v[152:155], v[164:167], v[60:63]
    v_mfma_f32_16x16x32_bf16 v[60:63], v[156:159], v[160:163], v[60:63]
    s_waitcnt lgkmcnt(0)
    v_mfma_f32_16x16x32_bf16 v[32:35], v[64:67], v[96:99], v[32:35]
    ds_read_b64 v[128:129], v20 offset:448
    v_mfma_f32_16x16x32_bf16 v[36:39], v[64:67], v[100:103], v[36:39]
    ds_read_b64 v[130:131], v20 offset:456
    v_mfma_f32_16x16x32_bf16 v[36:39], v[68:71], v[96:99], v[36:39]
    ds_read_b128 v[160:163], v21 offset:4032
    v_mfma_f32_16x16x32_bf16 v[40:43], v[64:67], v[104:107], v[40:43]
    ds_read_b64 v[132:133], v20 offset:960
    v_mfma_f32_16x16x32_bf16 v[40:43], v[68:71], v[100:103], v[40:43]
    ds_read_b64 v[134:135], v20 offset:968
    v_mfma_f32_16x16x32_bf16 v[40:43], v[72:75], v[96:99], v[40:43]
    ds_read_b128 v[164:167], v21 offset:3520
    v_mfma_f32_16x16x32_bf16 v[44:47], v[64:67], v[108:111], v[44:47]
    ds_read_b64 v[136:137], v20 offset:1472
    v_mfma_f32_16x16x32_bf16 v[44:47], v[68:71], v[104:107], v[44:47]
    ds_read_b64 v[138:139], v20 offset:1480
    v_mfma_f32_16x16x32_bf16 v[44:47], v[72:75], v[100:103], v[44:47]
    ds_read_b128 v[168:171], v21 offset:3008
    v_mfma_f32_16x16x32_bf16 v[44:47], v[76:79], v[96:99], v[44:47]
    ds_read_b64 v[140:141], v20 offset:1984
    v_mfma_f32_16x16x32_bf16 v[48:51], v[64:67], v[112:115], v[48:51]
    ds_read_b64 v[142:143], v20 offset:1992
    v_mfma_f32_16x16x32_bf16 v[48:51], v[68:71], v[108:111], v[48:51]
    ds_read_b128 v[172:175], v21 offset:2496
    v_mfma_f32_16x16x32_bf16 v[48:51], v[72:75], v[104:107], v[48:51]
    ds_read_b64 v[144:145], v20 offset:2496
    v_mfma_f32_16x16x32_bf16 v[48:51], v[76:79], v[100:103], v[48:51]
    ds_read_b64 v[146:147], v20 offset:2504
    v_mfma_f32_16x16x32_bf16 v[48:51], v[80:83], v[96:99], v[48:51]
    ds_read_b128 v[176:179], v21 offset:1984
    v_mfma_f32_16x16x32_bf16 v[52:55], v[64:67], v[116:119], v[52:55]
    ds_read_b64 v[148:149], v20 offset:3008
    v_mfma_f32_16x16x32_bf16 v[52:55], v[68:71], v[112:115], v[52:55]
    ds_read_b64 v[150:151], v20 offset:3016
    v_mfma_f32_16x16x32_bf16 v[52:55], v[72:75], v[108:111], v[52:55]
    ds_read_b128 v[180:183], v21 offset:1472
    v_mfma_f32_16x16x32_bf16 v[52:55], v[76:79], v[104:107], v[52:55]
    ds_read_b64 v[152:153], v20 offset:3520
    v_mfma_f32_16x16x32_bf16 v[52:55], v[80:83], v[100:103], v[52:55]
    ds_read_b64 v[154:155], v20 offset:3528
    v_mfma_f32_16x16x32_bf16 v[52:55], v[84:87], v[96:99], v[52:55]
    ds_read_b128 v[184:187], v21 offset:960
    v_mfma_f32_16x16x32_bf16 v[56:59], v[64:67], v[120:123], v[56:59]
    ds_read_b64 v[156:157], v20 offset:4032
    v_mfma_f32_16x16x32_bf16 v[56:59], v[68:71], v[116:119], v[56:59]
    ds_read_b64 v[158:159], v20 offset:4040
    v_mfma_f32_16x16x32_bf16 v[56:59], v[72:75], v[112:115], v[56:59]
    ds_read_b128 v[188:191], v21 offset:448
    v_mfma_f32_16x16x32_bf16 v[56:59], v[76:79], v[108:111], v[56:59]
    v_mfma_f32_16x16x32_bf16 v[56:59], v[80:83], v[104:107], v[56:59]
    v_mfma_f32_16x16x32_bf16 v[56:59], v[84:87], v[100:103], v[56:59]
    v_mfma_f32_16x16x32_bf16 v[56:59], v[88:91], v[96:99], v[56:59]
    v_mfma_f32_16x16x32_bf16 v[60:63], v[64:67], v[124:127], v[60:63]
    v_mfma_f32_16x16x32_bf16 v[60:63], v[68:71], v[120:123], v[60:63]
    v_mfma_f32_16x16x32_bf16 v[60:63], v[72:75], v[116:119], v[60:63]
    v_mfma_f32_16x16x32_bf16 v[60:63], v[76:79], v[112:115], v[60:63]
    v_mfma_f32_16x16x32_bf16 v[60:63], v[80:83], v[108:111], v[60:63]
    v_mfma_f32_16x16x32_bf16 v[60:63], v[84:87], v[104:107], v[60:63]
    v_mfma_f32_16x16x32_bf16 v[60:63], v[88:91], v[100:103], v[60:63]
    v_mfma_f32_16x16x32_bf16 v[60:63], v[92:95], v[96:99], v[60:63]
    s_waitcnt lgkmcnt(0)
    v_mfma_f32_16x16x32_bf16 v[60:63], v[128:131], v[188:191], v[60:63]
    v_mfma_f32_16x16x32_bf16 v[60:63], v[132:135], v[184:187], v[60:63]
    v_mfma_f32_16x16x32_bf16 v[60:63], v[136:139], v[180:183], v[60:63]
    v_mfma_f32_16x16x32_bf16 v[60:63], v[140:143], v[176:179], v[60:63]
    v_mfma_f32_16x16x32_bf16 v[60:63], v[144:147], v[172:175], v[60:63]
    v_mfma_f32_16x16x32_bf16 v[60:63], v[148:151], v[168:171], v[60:63]
    v_mfma_f32_16x16x32_bf16 v[60:63], v[152:155], v[164:167], v[60:63]
    v_mfma_f32_16x16x32_bf16 v[60:63], v[156:159], v[160:163], v[60:63]
    v_mfma_f32_16x16x32_bf16 v[56:59], v[128:131], v[184:187], v[56:59]
    v_mfma_f32_16x16x32_bf16 v[56:59], v[132:135], v[180:183], v[56:59]
    v_mfma_f32_16x16x32_bf16 v[56:59], v[136:139], v[176:179], v[56:59]
    v_mfma_f32_16x16x32_bf16 v[56:59], v[140:143], v[172:175], v[56:59]
    v_mfma_f32_16x16x32_bf16 v[56:59], v[144:147], v[168:171], v[56:59]
    v_mfma_f32_16x16x32_bf16 v[56:59], v[148:151], v[164:167], v[56:59]
    v_mfma_f32_16x16x32_bf16 v[56:59], v[152:155], v[160:163], v[56:59]
    v_mfma_f32_16x16x32_bf16 v[52:55], v[128:131], v[180:183], v[52:55]
    ds_write_b128 v23, v[60:63] offset:7168
    v_mfma_f32_16x16x32_bf16 v[52:55], v[132:135], v[176:179], v[52:55]
    v_mfma_f32_16x16x32_bf16 v[52:55], v[136:139], v[172:175], v[52:55]
    v_mfma_f32_16x16x32_bf16 v[52:55], v[140:143], v[168:171], v[52:55]
    v_mfma_f32_16x16x32_bf16 v[52:55], v[144:147], v[164:167], v[52:55]
    v_mfma_f32_16x16x32_bf16 v[52:55], v[148:151], v[160:163], v[52:55]
    v_mfma_f32_16x16x32_bf16 v[48:51], v[128:131], v[176:179], v[48:51]
    v_mfma_f32_16x16x32_bf16 v[48:51], v[132:135], v[172:175], v[48:51]
    ds_write_b128 v23, v[56:59] offset:6144
    v_mfma_f32_16x16x32_bf16 v[48:51], v[136:139], v[168:171], v[48:51]
    v_mfma_f32_16x16x32_bf16 v[48:51], v[140:143], v[164:167], v[48:51]
    v_mfma_f32_16x16x32_bf16 v[48:51], v[144:147], v[160:163], v[48:51]
    v_mfma_f32_16x16x32_bf16 v[44:47], v[128:131], v[172:175], v[44:47]
    v_mfma_f32_16x16x32_bf16 v[44:47], v[132:135], v[168:171], v[44:47]
    v_mfma_f32_16x16x32_bf16 v[44:47], v[136:139], v[164:167], v[44:47]
    ds_write_b128 v23, v[52:55] offset:5120
    v_mfma_f32_16x16x32_bf16 v[44:47], v[140:143], v[160:163], v[44:47]
    v_mfma_f32_16x16x32_bf16 v[40:43], v[128:131], v[168:171], v[40:43]
    v_mfma_f32_16x16x32_bf16 v[40:43], v[132:135], v[164:167], v[40:43]
    v_mfma_f32_16x16x32_bf16 v[40:43], v[136:139], v[160:163], v[40:43]
    v_mfma_f32_16x16x32_bf16 v[36:39], v[128:131], v[164:167], v[36:39]
    ds_write_b128 v23, v[48:51] offset:4096
    v_mfma_f32_16x16x32_bf16 v[36:39], v[132:135], v[160:163], v[36:39]
    v_mfma_f32_16x16x32_bf16 v[32:35], v[128:131], v[160:163], v[32:35]
    s_nop 7
    ds_write_b128 v23, v[44:47] offset:3072
    ds_write_b128 v23, v[40:43] offset:2048
    ds_write_b128 v23, v[36:39] offset:1024
    ds_write_b128 v23, v[32:35] offset:0
    s_waitcnt lgkmcnt(0)
    s_barrier
    s_branch K34_JOIN
K01_EPI0:
    v_and_b32 v112, 7, v2
    v_lshrrev_b32 v113, 3, v2
    s_lshl_b32 s27, s44, 4
    v_add_u32 v113, s27, v113
    s_movk_i32 s26, 2560
    v_mul_u32_u24 v114, s26, v113
    v_lshl_add_u32 v114, v112, 3, v114
    v_add_u32 v114, s25, v114
    v_add_u32 v115, 20480, v114
    v_lshlrev_b32 v116, 14, v112
    v_lshl_add_u32 v116, v113, 4, v116
    s_lshl_b32 s26, s15, 18
    s_lshl_b32 s27, s24, 10
    s_add_u32 s26, s26, s27
    s_add_u32 s26, s26, 2703360
    v_add_u32 v116, s26, v116
    s_add_u32 m0, s47, 4288
    s_nop 0
    global_load_lds_dwordx4 v3, s[50:51] offset:0
    global_load_lds_dwordx4 v3, s[50:51] offset:1024
    global_load_lds_dwordx4 v3, s[50:51] offset:2048
    global_load_lds_dwordx4 v3, s[50:51] offset:3072
    s_waitcnt vmcnt(23)
    v_lshlrev_b32 v40, 16, v32
    v_lshlrev_b32 v41, 16, v34
    v_and_b32 v42, 0xffff0000, v32
    v_and_b32 v43, 0xffff0000, v34
    v_lshlrev_b32 v44, 16, v33
    v_lshlrev_b32 v45, 16, v35
    v_and_b32 v46, 0xffff0000, v33
    v_and_b32 v47, 0xffff0000, v35
    s_waitcnt vmcnt(22)
    v_lshlrev_b32 v50, 16, v10
    v_and_b32 v51, 0xffff0000, v10
    s_waitcnt vmcnt(21)
    v_lshlrev_b32 v52, 16, v11
    v_and_b32 v53, 0xffff0000, v11
    s_waitcnt vmcnt(20)
    v_lshlrev_b32 v54, 16, v12
    v_and_b32 v55, 0xffff0000, v12
    s_waitcnt vmcnt(19)
    v_lshlrev_b32 v56, 16, v13
    v_and_b32 v57, 0xffff0000, v13
    s_waitcnt vmcnt(18)
    v_lshlrev_b32 v58, 16, v14
    v_and_b32 v59, 0xffff0000, v14
    s_waitcnt vmcnt(17)
    v_lshlrev_b32 v60, 16, v15
    v_and_b32 v61, 0xffff0000, v15
    s_waitcnt vmcnt(16)
    v_lshlrev_b32 v62, 16, v16
    v_and_b32 v63, 0xffff0000, v16
    s_waitcnt vmcnt(15)
    v_lshlrev_b32 v64, 16, v17
    v_and_b32 v65, 0xffff0000, v17
    s_waitcnt vmcnt(14)
    v_lshlrev_b32 v66, 16, v18
    v_and_b32 v67, 0xffff0000, v18
    s_waitcnt vmcnt(13)
    v_lshlrev_b32 v68, 16, v19
    v_and_b32 v69, 0xffff0000, v19
    s_waitcnt vmcnt(12)
    v_lshlrev_b32 v70, 16, v20
    v_and_b32 v71, 0xffff0000, v20
    v_pk_mul_f32 v[72:73], v[50:51], v[46:47]
    v_pk_mul_f32 v[74:75], v[52:53], v[46:47]
    v_pk_mul_f32 v[76:77], v[54:55], v[46:47]
    v_pk_mul_f32 v[78:79], v[56:57], v[46:47]
    v_pk_mul_f32 v[80:81], v[58:59], v[46:47]
    v_pk_mul_f32 v[82:83], v[60:61], v[46:47]
    v_pk_mul_f32 v[84:85], v[62:63], v[46:47]
    v_pk_mul_f32 v[86:87], v[64:65], v[46:47]
    v_pk_fma_f32 v[72:73], v[52:53], v[44:45], v[72:73]
    v_pk_fma_f32 v[74:75], v[54:55], v[44:45], v[74:75]
    v_pk_fma_f32 v[76:77], v[56:57], v[44:45], v[76:77]
    v_pk_fma_f32 v[78:79], v[58:59], v[44:45], v[78:79]
    v_pk_fma_f32 v[80:81], v[60:61], v[44:45], v[80:81]
    v_pk_fma_f32 v[82:83], v[62:63], v[44:45], v[82:83]
    v_pk_fma_f32 v[84:85], v[64:65], v[44:45], v[84:85]
    v_pk_fma_f32 v[86:87], v[66:67], v[44:45], v[86:87]
    v_pk_fma_f32 v[72:73], v[54:55], v[42:43], v[72:73]
    v_pk_fma_f32 v[74:75], v[56:57], v[42:43], v[74:75]
    v_pk_fma_f32 v[76:77], v[58:59], v[42:43], v[76:77]
    v_pk_fma_f32 v[78:79], v[60:61], v[42:43], v[78:79]
    v_pk_fma_f32 v[80:81], v[62:63], v[42:43], v[80:81]
    v_pk_fma_f32 v[82:83], v[64:65], v[42:43], v[82:83]
    v_pk_fma_f32 v[84:85], v[66:67], v[42:43], v[84:85]
    v_pk_fma_f32 v[86:87], v[68:69], v[42:43], v[86:87]
    v_pk_fma_f32 v[72:73], v[56:57], v[40:41], v[72:73]
    v_pk_fma_f32 v[74:75], v[58:59], v[40:41], v[74:75]
    v_pk_fma_f32 v[76:77], v[60:61], v[40:41], v[76:77]
    v_pk_fma_f32 v[78:79], v[62:63], v[40:41], v[78:79]
    v_pk_fma_f32 v[80:81], v[64:65], v[40:41], v[80:81]
    v_pk_fma_f32 v[82:83], v[66:67], v[40:41], v[82:83]
    v_pk_fma_f32 v[84:85], v[68:69], v[40:41], v[84:85]
    v_pk_fma_f32 v[86:87], v[70:71], v[40:41], v[86:87]
    s_waitcnt vmcnt(11)
    v_lshlrev_b32 v88, 16, v21
    v_and_b32 v89, 0xffff0000, v21
    s_waitcnt vmcnt(10)
    v_lshlrev_b32 v90, 16, v22
    v_and_b32 v91, 0xffff0000, v22
    s_waitcnt vmcnt(9)
    v_lshlrev_b32 v92, 16, v23
    v_and_b32 v93, 0xffff0000, v23
    s_waitcnt vmcnt(8)
    v_lshlrev_b32 v94, 16, v24
    v_and_b32 v95, 0xffff0000, v24
    s_waitcnt vmcnt(7)
    v_lshlrev_b32 v96, 16, v25
    v_and_b32 v97, 0xffff0000, v25
    s_waitcnt vmcnt(6)
    v_lshlrev_b32 v98, 16, v26
    v_and_b32 v99, 0xffff0000, v26
    s_waitcnt vmcnt(5)
    v_lshlrev_b32 v100, 16, v27
    v_and_b32 v101, 0xffff0000, v27
    s_waitcnt vmcnt(4)
    v_lshlrev_b32 v102, 16, v28
    v_and_b32 v103, 0xffff0000, v28
    v_pk_mul_f32 v[72:73], v[72:73], v[88:89]
    v_pk_mul_f32 v[74:75], v[74:75], v[90:91]
    v_pk_mul_f32 v[76:77], v[76:77], v[92:93]
    v_pk_mul_f32 v[78:79], v[78:79], v[94:95]
    v_pk_mul_f32 v[80:81], v[80:81], v[96:97]
    v_pk_mul_f32 v[82:83], v[82:83], v[98:99]
    v_pk_mul_f32 v[84:85], v[84:85], v[100:101]
    v_pk_mul_f32 v[86:87], v[86:87], v[102:103]
    v_cvt_pk_bf16_f32 v104, v86, v84
    v_cvt_pk_bf16_f32 v105, v82, v80
    v_cvt_pk_bf16_f32 v106, v78, v76
    v_cvt_pk_bf16_f32 v107, v74, v72
    v_cvt_pk_bf16_f32 v108, v87, v85
    v_cvt_pk_bf16_f32 v109, v83, v81
    v_cvt_pk_bf16_f32 v110, v79, v77
    v_cvt_pk_bf16_f32 v111, v75, v73
    ds_write_b128 v134, v[104:107]
    ds_write_b128 v134, v[108:111] offset:272
    v_mov_b32 v31, 103712
    ds_write_b128 v31, v[128:131]
    ds_write_b128 v31, v[128:131] offset:16
    v_and_b32 v4, 15, v2
    v_lshrrev_b32 v5, 4, v2
    v_and_b32 v6, 1, v4
    v_lshrrev_b32 v7, 1, v4
    v_lshlrev_b32 v8, 3, v5
    v_lshl_add_u32 v8, v6, 1, v8
    v_lshl_add_u32 v9, v7, 5, v8
    v_add_u32 v122, s47, v3
    s_waitcnt lgkmcnt(0)
    s_barrier
    s_waitcnt vmcnt(0)
    ds_read_b128 v[160:163], v122 offset:4288
    ds_read_b32 v164, v122 offset:4284
    ds_read_b128 v[168:171], v122 offset:5312
    ds_read_b32 v172, v122 offset:5308
    ds_read_b128 v[176:179], v122 offset:6336
    ds_read_b32 v180, v122 offset:6332
    ds_read_b128 v[184:187], v122 offset:7360
    ds_read_b32 v188, v122 offset:7356
    s_waitcnt lgkmcnt(6)
    v_alignbit_b32 v163, v163, v162, 16
    v_alignbit_b32 v162, v162, v161, 16
    v_alignbit_b32 v161, v161, v160, 16
    v_alignbit_b32 v160, v160, v164, 16
    ds_write_b128 v122, v[160:163] offset:64
    s_waitcnt lgkmcnt(5)
    v_alignbit_b32 v171, v171, v170, 16
    v_alignbit_b32 v170, v170, v169, 16
    v_alignbit_b32 v169, v169, v168, 16
    v_alignbit_b32 v168, v168, v172, 16
    ds_write_b128 v122, v[168:171] offset:1088
    s_waitcnt lgkmcnt(4)
    v_alignbit_b32 v179, v179, v178, 16
    v_alignbit_b32 v178, v178, v177, 16
    v_alignbit_b32 v177, v177, v176, 16
    v_alignbit_b32 v176, v176, v180, 16
    ds_write_b128 v122, v[176:179] offset:2112
    s_waitcnt lgkmcnt(3)
    v_alignbit_b32 v187, v187, v186, 16
    v_alignbit_b32 v186, v186, v185, 16
    v_alignbit_b32 v185, v185, v184, 16
    v_alignbit_b32 v184, v184, v188, 16
    ds_write_b128 v122, v[184:187] offset:3136
    s_waitcnt lgkmcnt(0)
    s_mov_b64 exec, 1
    ds_add_u32 v31, v119 offset:20
    s_mov_b64 exec, -1
    s_mov_b32 s35, 8000000
LW_XW:
    ds_read_b32 v30, v31 offset:0
    s_waitcnt lgkmcnt(0)
    v_readfirstlane_b32 s26, v30
    s_nop 1
    s_and_b32 s26, s26, 0xff
    s_cmp_ge_u32 s26, 4
    s_cbranch_scc1 LD_XW
    s_sleep 2
    s_sub_u32 s35, s35, 1
    s_cmp_lg_u32 s35, 0
    s_cbranch_scc1 LW_XW
LD_XW:
    global_load_dwordx2 v[140:141], v114, s[4:5] offset:0
    global_load_dwordx2 v[142:143], v114, s[4:5] offset:1280
    global_load_dwordx2 v[144:145], v115, s[4:5] offset:0
    global_load_dwordx2 v[146:147], v115, s[4:5] offset:1280
    global_load_dwordx2 v[148:149], v114, s[4:5] offset:64
    global_load_dwordx2 v[150:151], v114, s[4:5] offset:1344
    global_load_dwordx2 v[152:153], v115, s[4:5] offset:64
    global_load_dwordx2 v[154:155], v115, s[4:5] offset:1344
    s_lshl_b32 s26, s44, 12
    v_lshlrev_b32 v10, 3, v9
    v_add_u32 v10, s26, v10
    s_lshl_b32 s27, s3, 14
    s_add_u32 s27, s27, 2703360
    v_add_u32 v11, s27, v10
    v_add_u32 v12, 5324800, v10
    s_lshl_b32 s26, s44, 11
    s_add_u32 s26, s26, 70912
    v_add_u32 v24, s26, v3
    s_lshl_b32 s26, s44, 10
    s_sub_u32 s27, 42004, s26
    v_lshlrev_b32 v22, 1, v9
    v_sub_u32 v22, s27, v22
    v_and_b32 v25, 2, v2
    v_cmp_ne_u32 s[46:47], 0, v25
    v_add_u32 v13, 2637824, v11
    v_mov_b32 v14, -224
    v_mov_b32 v15, 256
    v_mov_b32 v16, 32
    v_cndmask_b32 v25, 0, v14, s[46:47]
    v_cndmask_b32 v26, v15, v16, s[46:47]
    v_add_u32 v25, v25, v13
    v_add_u32 v26, v26, v13
    s_mov_b32 s16, s4
    s_mov_b32 s17, s5
    s_lshl_b32 s4, s56, 16
    s_and_b32 s5, s56, 0xffff0000
    s_lshl_b32 s6, s57, 16
    s_and_b32 s7, s57, 0xffff0000
    s_and_b32 s26, s2, 7
    s_lshl_b32 s26, s26, 7
    s_add_u32 s26, s26, 20507136
    v_mov_b32 v27, s26
    v_add_u32 v28, 128, v117
    s_mov_b32 s32, 131072
    s_waitcnt vmcnt(6)
    buffer_store_dwordx4 v[140:143], v116, s[36:39], 0 offen sc1
    s_waitcnt vmcnt(5)
    buffer_store_dwordx4 v[144:147], v116, s[36:39], 0 offen offset:128 sc1
    s_waitcnt vmcnt(4)
    buffer_store_dwordx4 v[148:151], v116, s[36:39], s32 offen sc1
    s_waitcnt vmcnt(3)
    buffer_store_dwordx4 v[152:155], v116, s[36:39], s32 offen offset:128 sc1
    s_waitcnt vmcnt(0)
    s_mov_b64 exec, 1
    ds_add_rtn_u32 v30, v31, v119 offset:12
    s_mov_b64 exec, -1
    s_waitcnt lgkmcnt(0)
    v_readfirstlane_b32 s52, v30
    s_nop 1
    s_cmp_lg_u32 s52, 3
    s_cbranch_scc1 K01_NOXA
    s_mov_b32 s35, 8000000
LW_GO2:
    ds_read_b32 v30, v31 offset:4
    s_waitcnt lgkmcnt(0)
    v_readfirstlane_b32 s26, v30
    s_nop 1
    s_cmp_ge_u32 s26, 1
    s_cbranch_scc1 LD_GO2
    s_sleep 2
    s_sub_u32 s35, s35, 1
    s_cmp_lg_u32 s35, 0
    s_cbranch_scc1 LW_GO2
LD_GO2:
    s_mov_b64 exec, 1
    buffer_atomic_add v119, v28, s[36:39], 0 offen
    s_mov_b64 exec, -1
K01_NOXA:
    s_mov_b32 s35, 8000000
LW_UL:
    ds_read_b32 v30, v31 offset:16
    s_waitcnt lgkmcnt(0)
    v_readfirstlane_b32 s26, v30
    s_nop 1
    s_cmp_ge_u32 s26, 4
    s_cbranch_scc1 LD_UL
    s_sleep 2
    s_sub_u32 s35, s35, 1
    s_cmp_lg_u32 s35, 0
    s_cbranch_scc1 LW_UL
LD_UL:
    ds_read_b32 v208, v22 offset:520
    ds_read_b32 v209, v22 offset:512
    ds_read_b32 v210, v22 offset:9800
    ds_read_b32 v211, v22 offset:9792
    ds_read_b32 v212, v22 offset:19080
    ds_read_b32 v213, v22 offset:19072
    ds_read_b32 v214, v22 offset:28360
    ds_read_b32 v215, v22 offset:28352
    ds_read_b32 v216, v22 offset:8
    ds_read_b32 v217, v22 offset:0
    ds_read_b32 v218, v22 offset:9288
    ds_read_b32 v219, v22 offset:9280
    ds_read_b32 v220, v22 offset:18568
    ds_read_b32 v221, v22 offset:18560
    ds_read_b32 v222, v22 offset:27848
    ds_read_b32 v223, v22 offset:27840
    s_setprio 1
    s_waitcnt lgkmcnt(0)
    v_and_b32 v160, 0xffff0000, v208
    v_lshlrev_b32 v161, 16, v208
    v_and_b32 v162, 0xffff0000, v209
    v_lshlrev_b32 v163, 16, v209
    v_mul_f32 v160, s4, v160
    v_mul_f32 v161, s4, v161
    v_mul_f32 v162, s4, v162
    v_mul_f32 v163, s4, v163
    v_and_b32 v164, 0xffff0000, v210
    v_lshlrev_b32 v165, 16, v210
    v_and_b32 v166, 0xffff0000, v211
    v_lshlrev_b32 v167, 16, v211
    v_mul_f32 v164, s5, v164
    v_mul_f32 v165, s5, v165
    v_mul_f32 v166, s5, v166
    v_mul_f32 v167, s5, v167
    v_and_b32 v168, 0xffff0000, v212
    v_lshlrev_b32 v169, 16, v212
    v_and_b32 v170, 0xffff0000, v213
    v_lshlrev_b32 v171, 16, v213
    v_mul_f32 v168, s6, v168
    v_mul_f32 v169, s6, v169
    v_mul_f32 v170, s6, v170
    v_mul_f32 v171, s6, v171
    v_and_b32 v172, 0xffff0000, v214
    v_lshlrev_b32 v173, 16, v214
    v_and_b32 v174, 0xffff0000, v215
    v_lshlrev_b32 v175, 16, v215
    v_mul_f32 v172, s7, v172
    v_mul_f32 v173, s7, v173
    v_mul_f32 v174, s7, v174
    v_mul_f32 v175, s7, v175
    v_and_b32 v176, 0xffff0000, v216
    v_lshlrev_b32 v177, 16, v216
    v_and_b32 v178, 0xffff0000, v217
    v_lshlrev_b32 v179, 16, v217
    v_mul_f32 v176, s4, v176
    v_mul_f32 v177, s4, v177
    v_mul_f32 v178, s4, v178
    v_mul_f32 v179, s4, v179
    v_and_b32 v180, 0xffff0000, v218
    v_lshlrev_b32 v181, 16, v218
    v_and_b32 v182, 0xffff0000, v219
    v_lshlrev_b32 v183, 16, v219
    v_mul_f32 v180, s5, v180
    v_mul_f32 v181, s5, v181
    v_mul_f32 v182, s5, v182
    v_mul_f32 v183, s5, v183
    v_and_b32 v184, 0xffff0000, v220
    v_lshlrev_b32 v185, 16, v220
    v_and_b32 v186, 0xffff0000, v221
    v_lshlrev_b32 v187, 16, v221
    v_mul_f32 v184, s6, v184
    v_mul_f32 v185, s6, v185
    v_mul_f32 v186, s6, v186
    v_mul_f32 v187, s6, v187
    v_and_b32 v188, 0xffff0000, v222
    v_lshlrev_b32 v189, 16, v222
    v_and_b32 v190, 0xffff0000, v223
    v_lshlrev_b32 v191, 16, v223
    v_mul_f32 v188, s7, v188
    v_mul_f32 v189, s7, v189
    v_mul_f32 v190, s7, v190
    v_mul_f32 v191, s7, v191
    s_cmp_lg_u32 s14, 4
    s_cbranch_scc1 K01_LWAIT
    s_lshr_b32 s34, s2, 3
    s_cmp_ge_u32 s34, 17
    s_cbranch_scc1 PF_SKIP_K1
    s_getpc_b64 s[32:33]
PF_PC_K1:
    s_add_u32 s32, s32, K34_CODE-PF_PC_K1
    s_addc_u32 s33, s33, 0
    s_lshl_b32 s34, s34, 10
    v_lshlrev_b32 v29, 4, v2
    v_add_u32 v29, s34, v29
    global_load_dwordx4 v[224:227], v29, s[32:33]
PF_SKIP_K1:
    s_mov_b32 s35, 400000
SPIN_STAT:
    buffer_load_dword v30, v27, s[36:39], 0 offen sc1
    s_waitcnt vmcnt(0)
    v_cmp_le_u32 vcc, 48, v30
    s_nop 1
    s_cmp_eq_u64 vcc, -1
    s_cbranch_scc1 SPUN_STAT
    s_sleep 4
    s_sub_u32 s35, s35, 1
    s_cmp_lg_u32 s35, 0
    s_cbranch_scc1 SPIN_STAT
SPUN_STAT:
    s_mov_b32 s35, 400000
SPIN_XRDY:
    buffer_load_dword v30, v28, s[36:39], 0 offen sc1
    s_waitcnt vmcnt(0)
    v_cmp_le_u32 vcc, 16, v30
    s_nop 1
    s_cmp_eq_u64 vcc, -1
    s_cbranch_scc1 SPUN_XRDY
    s_sleep 2
    s_sub_u32 s35, s35, 1
    s_cmp_lg_u32 s35, 0
    s_cbranch_scc1 SPIN_XRDY
SPUN_XRDY:
    ds_write_b32 v31, v119 offset:8
    s_branch K01_LGO
K01_LWAIT:
    s_mov_b32 s35, 8000000
LW_LG:
    ds_read_b32 v30, v31 offset:8
    s_waitcnt lgkmcnt(0)
    v_readfirstlane_b32 s26, v30
    s_nop 1
    s_cmp_ge_u32 s26, 1
    s_cbranch_scc1 LD_LG
    s_sleep 2
    s_sub_u32 s35, s35, 1
    s_cmp_lg_u32 s35, 0
    s_cbranch_scc1 LW_LG
LD_LG:
K01_LGO:
    global_load_dwordx4 v[64:67], v11, s[12:13] offset:0
    global_load_dwordx4 v[68:71], v11, s[12:13] offset:32
    global_load_dwordx4 v[72:75], v11, s[12:13] offset:2048
    global_load_dwordx4 v[76:79], v11, s[12:13] offset:2080
    global_load_dwordx4 v[80:83], v12, s[12:13] offset:0
    global_load_dwordx4 v[84:87], v12, s[12:13] offset:32
    global_load_dwordx4 v[88:91], v12, s[12:13] offset:2048
    global_load_dwordx4 v[92:95], v12, s[12:13] offset:2080
    s_waitcnt vmcnt(4)
    v_lshlrev_b32 v96, 16, v64
    v_and_b32 v97, 0xffff0000, v64
    v_lshlrev_b32 v98, 16, v65
    v_and_b32 v99, 0xffff0000, v65
    v_lshlrev_b32 v100, 16, v66
    v_and_b32 v101, 0xffff0000, v66
    v_lshlrev_b32 v102, 16, v67
    v_and_b32 v103, 0xffff0000, v67
    v_lshlrev_b32 v104, 16, v68
    v_and_b32 v105, 0xffff0000, v68
    v_lshlrev_b32 v106, 16, v69
    v_and_b32 v107, 0xffff0000, v69
    v_lshlrev_b32 v108, 16, v70
    v_and_b32 v109, 0xffff0000, v70
    v_lshlrev_b32 v110, 16, v71
    v_and_b32 v111, 0xffff0000, v71
    v_lshlrev_b32 v112, 16, v72
    v_and_b32 v113, 0xffff0000, v72
    v_lshlrev_b32 v114, 16, v73
    v_and_b32 v115, 0xffff0000, v73
    v_lshlrev_b32 v116, 16, v74
    v_and_b32 v117, 0xffff0000, v74
    v_lshlrev_b32 v118, 16, v75
    v_and_b32 v119, 0xffff0000, v75
    v_lshlrev_b32 v120, 16, v76
    v_and_b32 v121, 0xffff0000, v76
    v_lshlrev_b32 v122, 16, v77
    v_and_b32 v123, 0xffff0000, v77
    v_lshlrev_b32 v124, 16, v78
    v_and_b32 v125, 0xffff0000, v78
    v_lshlrev_b32 v126, 16, v79
    v_and_b32 v127, 0xffff0000, v79
    s_waitcnt vmcnt(0)
    v_fma_f32 v128, v96, v80, v81
    v_fma_f32 v129, v97, v80, v81
    v_fma_f32 v130, v98, v80, v81
    v_fma_f32 v131, v99, v80, v81
    v_fma_f32 v96, v128, v160, v96
    v_fma_f32 v97, v129, v164, v97
    v_fma_f32 v98, v130, v168, v98
    v_fma_f32 v99, v131, v172, v99
    v_fma_f32 v132, v100, v82, v83
    v_fma_f32 v133, v101, v82, v83
    v_fma_f32 v134, v102, v82, v83
    v_fma_f32 v135, v103, v82, v83
    v_fma_f32 v100, v132, v161, v100
    v_fma_f32 v101, v133, v165, v101
    v_fma_f32 v102, v134, v169, v102
    v_fma_f32 v103, v135, v173, v103
    v_fma_f32 v136, v104, v84, v85
    v_fma_f32 v137, v105, v84, v85
    v_fma_f32 v138, v106, v84, v85
    v_fma_f32 v139, v107, v84, v85
    v_fma_f32 v104, v136, v162, v104
    v_fma_f32 v105, v137, v166, v105
    v_fma_f32 v106, v138, v170, v106
    v_fma_f32 v107, v139, v174, v107
    v_fma_f32 v140, v108, v86, v87
    v_fma_f32 v141, v109, v86, v87
    v_fma_f32 v142, v110, v86, v87
    v_fma_f32 v143, v111, v86, v87
    v_fma_f32 v108, v140, v163, v108
    v_fma_f32 v109, v141, v167, v109
    v_fma_f32 v110, v142, v171, v110
    v_fma_f32 v111, v143, v175, v111
    v_fma_f32 v144, v112, v88, v89
    v_fma_f32 v145, v113, v88, v89
    v_fma_f32 v146, v114, v88, v89
    v_fma_f32 v147, v115, v88, v89
    v_fma_f32 v112, v144, v176, v112
    v_fma_f32 v113, v145, v180, v113
    v_fma_f32 v114, v146, v184, v114
    v_fma_f32 v115, v147, v188, v115
    v_fma_f32 v148, v116, v90, v91
    v_fma_f32 v149, v117, v90, v91
    v_fma_f32 v150, v118, v90, v91
    v_fma_f32 v151, v119, v90, v91
    v_fma_f32 v116, v148, v177, v116
    v_fma_f32 v117, v149, v181, v117
    v_fma_f32 v118, v150, v185, v118
    v_fma_f32 v119, v151, v189, v119
    v_fma_f32 v152, v120, v92, v93
    v_fma_f32 v153, v121, v92, v93
    v_fma_f32 v154, v122, v92, v93
    v_fma_f32 v155, v123, v92, v93
    v_fma_f32 v120, v152, v178, v120
    v_fma_f32 v121, v153, v182, v121
    v_fma_f32 v122, v154, v186, v122
    v_fma_f32 v123, v155, v190, v123
    v_fma_f32 v156, v124, v94, v95
    v_fma_f32 v157, v125, v94, v95
    v_fma_f32 v158, v126, v94, v95
    v_fma_f32 v159, v127, v94, v95
    v_fma_f32 v124, v156, v179, v124
    v_fma_f32 v125, v157, v183, v125
    v_fma_f32 v126, v158, v187, v126
    v_fma_f32 v127, v159, v191, v127
    s_barrier
    ds_read_b128 v[160:163], v24 offset:0
    ds_read_b128 v[164:167], v24 offset:8192
    ds_read_b128 v[168:171], v24 offset:16384
    ds_read_b128 v[172:175], v24 offset:24576
    ds_read_b128 v[176:179], v24 offset:1024
    ds_read_b128 v[180:183], v24 offset:9216
    ds_read_b128 v[184:187], v24 offset:17408
    ds_read_b128 v[188:191], v24 offset:25600
    s_waitcnt lgkmcnt(4)
    v_fma_f32 v96, v128, v160, v96
    v_fma_f32 v97, v129, v164, v97
    v_fma_f32 v98, v130, v168, v98
    v_fma_f32 v99, v131, v172, v99
    v_cvt_pk_bf16_f32 v192, v96, v97
    v_cvt_pk_bf16_f32 v193, v98, v99
    v_fma_f32 v100, v132, v161, v100
    v_fma_f32 v101, v133, v165, v101
    v_fma_f32 v102, v134, v169, v102
    v_fma_f32 v103, v135, v173, v103
    v_cvt_pk_bf16_f32 v194, v100, v101
    v_cvt_pk_bf16_f32 v195, v102, v103
    v_fma_f32 v104, v136, v162, v104
    v_fma_f32 v105, v137, v166, v105
    v_fma_f32 v106, v138, v170, v106
    v_fma_f32 v107, v139, v174, v107
    v_cvt_pk_bf16_f32 v196, v104, v105
    v_cvt_pk_bf16_f32 v197, v106, v107
    v_fma_f32 v108, v140, v163, v108
    v_fma_f32 v109, v141, v167, v109
    v_fma_f32 v110, v142, v171, v110
    v_fma_f32 v111, v143, v175, v111
    v_cvt_pk_bf16_f32 v198, v108, v109
    v_cvt_pk_bf16_f32 v199, v110, v111
    v_cndmask_b32 v64, v196, v192, s[46:47]
    v_cndmask_b32 v65, v197, v193, s[46:47]
    v_cndmask_b32 v66, v198, v194, s[46:47]
    v_cndmask_b32 v67, v199, v195, s[46:47]
    v_mov_b32_dpp v64, v64 quad_perm:[2,3,0,1] row_mask:0xf bank_mask:0xf
    v_mov_b32_dpp v65, v65 quad_perm:[2,3,0,1] row_mask:0xf bank_mask:0xf
    v_mov_b32_dpp v66, v66 quad_perm:[2,3,0,1] row_mask:0xf bank_mask:0xf
    v_mov_b32_dpp v67, v67 quad_perm:[2,3,0,1] row_mask:0xf bank_mask:0xf
    v_cndmask_b32 v68, v192, v64, s[46:47]
    v_cndmask_b32 v69, v193, v65, s[46:47]
    v_cndmask_b32 v70, v194, v66, s[46:47]
    v_cndmask_b32 v71, v195, v67, s[46:47]
    global_store_dwordx4 v25, v[68:71], s[12:13] offset:0 sc1
    v_cndmask_b32 v72, v64, v196, s[46:47]
    v_cndmask_b32 v73, v65, v197, s[46:47]
    v_cndmask_b32 v74, v66, v198, s[46:47]
    v_cndmask_b32 v75, v67, v199, s[46:47]
    global_store_dwordx4 v26, v[72:75], s[12:13] offset:0 sc1
    s_waitcnt lgkmcnt(0)
    v_fma_f32 v112, v144, v176, v112
    v_fma_f32 v113, v145, v180, v113
    v_fma_f32 v114, v146, v184, v114
    v_fma_f32 v115, v147, v188, v115
    v_cvt_pk_bf16_f32 v200, v112, v113
    v_cvt_pk_bf16_f32 v201, v114, v115
    v_fma_f32 v116, v148, v177, v116
    v_fma_f32 v117, v149, v181, v117
    v_fma_f32 v118, v150, v185, v118
    v_fma_f32 v119, v151, v189, v119
    v_cvt_pk_bf16_f32 v202, v116, v117
    v_cvt_pk_bf16_f32 v203, v118, v119
    v_fma_f32 v120, v152, v178, v120
    v_fma_f32 v121, v153, v182, v121
    v_fma_f32 v122, v154, v186, v122
    v_fma_f32 v123, v155, v190, v123
    v_cvt_pk_bf16_f32 v204, v120, v121
    v_cvt_pk_bf16_f32 v205, v122, v123
    v_fma_f32 v124, v156, v179, v124
    v_fma_f32 v125, v157, v183, v125
    v_fma_f32 v126, v158, v187, v126
    v_fma_f32 v127, v159, v191, v127
    v_cvt_pk_bf16_f32 v206, v124, v125
    v_cvt_pk_bf16_f32 v207, v126, v127
    v_cndmask_b32 v76, v204, v200, s[46:47]
    v_cndmask_b32 v77, v205, v201, s[46:47]
    v_cndmask_b32 v78, v206, v202, s[46:47]
    v_cndmask_b32 v79, v207, v203, s[46:47]
    v_mov_b32_dpp v76, v76 quad_perm:[2,3,0,1] row_mask:0xf bank_mask:0xf
    v_mov_b32_dpp v77, v77 quad_perm:[2,3,0,1] row_mask:0xf bank_mask:0xf
    v_mov_b32_dpp v78, v78 quad_perm:[2,3,0,1] row_mask:0xf bank_mask:0xf
    v_mov_b32_dpp v79, v79 quad_perm:[2,3,0,1] row_mask:0xf bank_mask:0xf
    v_cndmask_b32 v80, v200, v76, s[46:47]
    v_cndmask_b32 v81, v201, v77, s[46:47]
    v_cndmask_b32 v82, v202, v78, s[46:47]
    v_cndmask_b32 v83, v203, v79, s[46:47]
    global_store_dwordx4 v25, v[80:83], s[12:13] offset:2048 sc1
    v_cndmask_b32 v84, v76, v204, s[46:47]
    v_cndmask_b32 v85, v77, v205, s[46:47]
    v_cndmask_b32 v86, v78, v206, s[46:47]
    v_cndmask_b32 v87, v79, v207, s[46:47]
    global_store_dwordx4 v26, v[84:87], s[12:13] offset:2048 sc1
    s_branch K34_JOIN
K01_STATS:
    s_load_dwordx2 s[24:25], s[0:1], 0
    s_load_dwordx2 s[20:21], s[0:1], 88
    s_sub_u32 s3, s2, 160
    v_lshlrev_b32 v4, 4, v2
    v_lshlrev_b32 v5, 2, v2
    s_mov_b32 s18, 2621440
    s_mov_b32 s19, 0x20000
    s_mov_b32 s38, 20512768
    s_mov_b32 s39, 0x20000
    s_mov_b32 s42, 256
    s_mov_b32 s43, 0x20000
    s_waitcnt lgkmcnt(0)
    s_mov_b32 s16, s24
    s_mov_b32 s17, s25
    s_mov_b32 s36, s12
    s_mov_b32 s37, s13
    s_mov_b32 s40, s20
    s_mov_b32 s41, s21
    v_mov_b32 v8, 0
    v_mov_b32 v9, 1
    s_or_b32 s26, s3, s14
    s_cmp_lg_u32 s26, 0
    s_cbranch_scc1 K01_SNL
    v_lshlrev_b32 v6, 7, v2
    v_add_u32 v6, 20504576, v6
    buffer_store_dword v8, v6, s[36:39], 0 offen sc1
    s_waitcnt vmcnt(0)
    s_mov_b64 exec, 1
    buffer_store_dword v9, v8, s[40:43], 0 offen sc1
    s_mov_b64 exec, -1
K01_SNL:
    s_cmp_ge_u32 s2, 208
    s_cbranch_scc1 K01_RF2
    s_cmp_lg_u32 s14, 4
    s_cbranch_scc1 K01_RF
    s_mov_b32 s35, 400000
SPIN_SR1:
    buffer_load_dword v7, v8, s[40:43], 0 offen sc1
    s_waitcnt vmcnt(0)
    v_cmp_le_u32 vcc, 1, v7
    s_nop 1
    s_cmp_eq_u64 vcc, -1
    s_cbranch_scc1 SPUN_SR1
    s_sleep 8
    s_sub_u32 s35, s35, 1
    s_cmp_lg_u32 s35, 0
    s_cbranch_scc1 SPIN_SR1
SPUN_SR1:
K01_RF:
    s_barrier
K01_RF2:
    s_cmp_lt_u32 s2, 208
    s_cbranch_scc1 K01_PBACK
    s_sub_u32 s3, s2, 208
    s_lshl_b32 s44, s3, 3
    s_add_u32 s44, s44, s14
    s_add_u32 s26, s44, 0
    s_mul_i32 s26, s26, 2560
    buffer_load_dwordx4 v[64:67], v4, s[16:19], s26 offen
    buffer_load_dword v68, v5, s[16:19], s26 offen offset:1024
    buffer_load_dwordx4 v[70:73], v4, s[16:19], s26 offen offset:1280
    buffer_load_dword v74, v5, s[16:19], s26 offen offset:2304
    s_add_u32 s26, s44, 384
    s_mul_i32 s26, s26, 2560
    buffer_load_dwordx4 v[76:79], v4, s[16:19], s26 offen
    buffer_load_dword v80, v5, s[16:19], s26 offen offset:1024
    buffer_load_dwordx4 v[82:85], v4, s[16:19], s26 offen offset:1280
    buffer_load_dword v86, v5, s[16:19], s26 offen offset:2304
    s_add_u32 s26, s44, 768
    s_mul_i32 s26, s26, 2560
    buffer_load_dwordx4 v[88:91], v4, s[16:19], s26 offen
    buffer_load_dword v92, v5, s[16:19], s26 offen offset:1024
    buffer_load_dwordx4 v[94:97], v4, s[16:19], s26 offen offset:1280
    buffer_load_dword v98, v5, s[16:19], s26 offen offset:2304
    s_cmp_ge_u32 s3, 128
    s_cbranch_scc1 K01_SDONE
    s_waitcnt vmcnt(8)
    v_lshlrev_b32 v24, 16, v64
    v_and_b32 v25, 0xffff0000, v64
    v_lshlrev_b32 v26, 16, v65
    v_and_b32 v27, 0xffff0000, v65
    v_lshlrev_b32 v28, 16, v66
    v_and_b32 v29, 0xffff0000, v66
    v_lshlrev_b32 v30, 16, v67
    v_and_b32 v31, 0xffff0000, v67
    v_lshlrev_b32 v32, 16, v68
    v_and_b32 v33, 0xffff0000, v68
    v_lshlrev_b32 v36, 16, v70
    v_and_b32 v37, 0xffff0000, v70
    v_lshlrev_b32 v38, 16, v71
    v_and_b32 v39, 0xffff0000, v71
    v_lshlrev_b32 v40, 16, v72
    v_and_b32 v41, 0xffff0000, v72
    v_lshlrev_b32 v42, 16, v73
    v_and_b32 v43, 0xffff0000, v73
    v_lshlrev_b32 v44, 16, v74
    v_and_b32 v45, 0xffff0000, v74
    s_lshl_b32 s15, s44, 4
    s_add_u32 s15, s15, 0
    v_pk_add_f32 v[48:49], v[24:25], v[26:27]
    v_pk_add_f32 v[50:51], v[28:29], v[30:31]
    v_pk_add_f32 v[48:49], v[48:49], v[32:33]
    v_pk_add_f32 v[48:49], v[48:49], v[50:51]
    v_add_f32 v48, v48, v49
    v_pk_add_f32 v[52:53], v[36:37], v[38:39]
    v_pk_add_f32 v[54:55], v[40:41], v[42:43]
    v_pk_add_f32 v[52:53], v[52:53], v[44:45]
    v_pk_add_f32 v[52:53], v[52:53], v[54:55]
    v_add_f32 v52, v52, v53
    s_nop 1
    v_add_f32_dpp v48, v48, v48 quad_perm:[1,0,3,2] row_mask:0xf bank_mask:0xf
    v_add_f32_dpp v52, v52, v52 quad_perm:[1,0,3,2] row_mask:0xf bank_mask:0xf
    s_nop 1
    v_add_f32_dpp v48, v48, v48 quad_perm:[2,3,0,1] row_mask:0xf bank_mask:0xf
    v_add_f32_dpp v52, v52, v52 quad_perm:[2,3,0,1] row_mask:0xf bank_mask:0xf
    s_nop 1
    v_add_f32_dpp v48, v48, v48 row_half_mirror row_mask:0xf bank_mask:0xf
    v_add_f32_dpp v52, v52, v52 row_half_mirror row_mask:0xf bank_mask:0xf
    s_nop 1
    v_add_f32_dpp v48, v48, v48 row_mirror row_mask:0xf bank_mask:0xf
    v_add_f32_dpp v52, v52, v52 row_mirror row_mask:0xf bank_mask:0xf
    s_nop 1
    v_add_f32_dpp v48, v48, v48 row_bcast:15 row_mask:0xa bank_mask:0xf
    v_add_f32_dpp v52, v52, v52 row_bcast:15 row_mask:0xa bank_mask:0xf
    s_nop 1
    v_add_f32_dpp v48, v48, v48 row_bcast:31 row_mask:0xc bank_mask:0xf
    v_add_f32_dpp v52, v52, v52 row_bcast:31 row_mask:0xc bank_mask:0xf
    v_mul_f32 v48, 0x3acccccd, v48
    v_mul_f32 v52, 0x3acccccd, v52
    s_nop 0
    v_readlane_b32 s20, v48, 63
    v_readlane_b32 s21, v52, 63
    s_nop 1
    v_subrev_f32 v24, s20, v24
    v_subrev_f32 v25, s20, v25
    v_subrev_f32 v26, s20, v26
    v_subrev_f32 v27, s20, v27
    v_subrev_f32 v28, s20, v28
    v_subrev_f32 v29, s20, v29
    v_subrev_f32 v30, s20, v30
    v_subrev_f32 v31, s20, v31
    v_subrev_f32 v32, s20, v32
    v_subrev_f32 v33, s20, v33
    v_subrev_f32 v36, s21, v36
    v_subrev_f32 v37, s21, v37
    v_subrev_f32 v38, s21, v38
    v_subrev_f32 v39, s21, v39
    v_subrev_f32 v40, s21, v40
    v_subrev_f32 v41, s21, v41
    v_subrev_f32 v42, s21, v42
    v_subrev_f32 v43, s21, v43
    v_subrev_f32 v44, s21, v44
    v_subrev_f32 v45, s21, v45
    v_pk_mul_f32 v[48:49], v[24:25], v[24:25]
    v_pk_fma_f32 v[48:49], v[26:27], v[26:27], v[48:49]
    v_pk_fma_f32 v[48:49], v[28:29], v[28:29], v[48:49]
    v_pk_fma_f32 v[48:49], v[30:31], v[30:31], v[48:49]
    v_pk_fma_f32 v[48:49], v[32:33], v[32:33], v[48:49]
    v_add_f32 v48, v48, v49
    v_pk_mul_f32 v[52:53], v[36:37], v[36:37]
    v_pk_fma_f32 v[52:53], v[38:39], v[38:39], v[52:53]
    v_pk_fma_f32 v[52:53], v[40:41], v[40:41], v[52:53]
    v_pk_fma_f32 v[52:53], v[42:43], v[42:43], v[52:53]
    v_pk_fma_f32 v[52:53], v[44:45], v[44:45], v[52:53]
    v_add_f32 v52, v52, v53
    s_nop 1
    v_add_f32_dpp v48, v48, v48 quad_perm:[1,0,3,2] row_mask:0xf bank_mask:0xf
    v_add_f32_dpp v52, v52, v52 quad_perm:[1,0,3,2] row_mask:0xf bank_mask:0xf
    s_nop 1
    v_add_f32_dpp v48, v48, v48 quad_perm:[2,3,0,1] row_mask:0xf bank_mask:0xf
    v_add_f32_dpp v52, v52, v52 quad_perm:[2,3,0,1] row_mask:0xf bank_mask:0xf
    s_nop 1
    v_add_f32_dpp v48, v48, v48 row_half_mirror row_mask:0xf bank_mask:0xf
    v_add_f32_dpp v52, v52, v52 row_half_mirror row_mask:0xf bank_mask:0xf
    s_nop 1
    v_add_f32_dpp v48, v48, v48 row_mirror row_mask:0xf bank_mask:0xf
    v_add_f32_dpp v52, v52, v52 row_mirror row_mask:0xf bank_mask:0xf
    s_nop 1
    v_add_f32_dpp v48, v48, v48 row_bcast:15 row_mask:0xa bank_mask:0xf
    v_add_f32_dpp v52, v52, v52 row_bcast:15 row_mask:0xa bank_mask:0xf
    s_nop 1
    v_add_f32_dpp v48, v48, v48 row_bcast:31 row_mask:0xc bank_mask:0xf
    v_add_f32_dpp v52, v52, v52 row_bcast:31 row_mask:0xc bank_mask:0xf
    v_mul_f32 v48, 0x3acccccd, v48
    v_mul_f32 v52, 0x3acccccd, v52
    s_nop 0
    v_readlane_b32 s22, v48, 63
    v_readlane_b32 s23, v52, 63
    s_nop 1
    v_mov_b32 v56, s20
    v_mov_b32 v57, s22
    v_writelane_b32 v56, s21, 1
    v_writelane_b32 v57, s23, 1
    s_nop 1
    v_cvt_pk_bf16_f32 v56, v56, v56
    v_lshlrev_b32 v56, 16, v56
    v_cvt_pk_bf16_f32 v57, v57, v57
    v_lshlrev_b32 v57, 16, v57
    v_add_f32 v57, 0x3727c5ac, v57
    v_cvt_pk_bf16_f32 v57, v57, v57
    v_lshlrev_b32 v57, 16, v57
    v_sqrt_f32 v57, v57
    s_nop 0
    v_cvt_pk_bf16_f32 v57, v57, v57
    v_lshlrev_b32 v57, 16, v57
    v_rcp_f32 v58, v57
    s_add_u32 s15, s15, 5324800
    v_lshlrev_b32 v10, 3, v2
    v_add_u32 v10, s15, v10
    v_mul_f32 v59, v56, v58
    v_sub_f32 v59, 0, v59
    s_mov_b64 exec, 3
    global_store_dwordx2 v10, v[58:59], s[12:13] sc1
    s_mov_b64 exec, -1
    s_add_u32 s3, s3, 48
    s_cmp_ge_u32 s3, 128
    s_cbranch_scc1 K01_SDONE
    s_waitcnt vmcnt(5)
    v_lshlrev_b32 v24, 16, v76
    v_and_b32 v25, 0xffff0000, v76
    v_lshlrev_b32 v26, 16, v77
    v_and_b32 v27, 0xffff0000, v77
    v_lshlrev_b32 v28, 16, v78
    v_and_b32 v29, 0xffff0000, v78
    v_lshlrev_b32 v30, 16, v79
    v_and_b32 v31, 0xffff0000, v79
    v_lshlrev_b32 v32, 16, v80
    v_and_b32 v33, 0xffff0000, v80
    v_lshlrev_b32 v36, 16, v82
    v_and_b32 v37, 0xffff0000, v82
    v_lshlrev_b32 v38, 16, v83
    v_and_b32 v39, 0xffff0000, v83
    v_lshlrev_b32 v40, 16, v84
    v_and_b32 v41, 0xffff0000, v84
    v_lshlrev_b32 v42, 16, v85
    v_and_b32 v43, 0xffff0000, v85
    v_lshlrev_b32 v44, 16, v86
    v_and_b32 v45, 0xffff0000, v86
    s_lshl_b32 s15, s44, 4
    s_add_u32 s15, s15, 6144
    v_pk_add_f32 v[48:49], v[24:25], v[26:27]
    v_pk_add_f32 v[50:51], v[28:29], v[30:31]
    v_pk_add_f32 v[48:49], v[48:49], v[32:33]
    v_pk_add_f32 v[48:49], v[48:49], v[50:51]
    v_add_f32 v48, v48, v49
    v_pk_add_f32 v[52:53], v[36:37], v[38:39]
    v_pk_add_f32 v[54:55], v[40:41], v[42:43]
    v_pk_add_f32 v[52:53], v[52:53], v[44:45]
    v_pk_add_f32 v[52:53], v[52:53], v[54:55]
    v_add_f32 v52, v52, v53
    s_nop 1
    v_add_f32_dpp v48, v48, v48 quad_perm:[1,0,3,2] row_mask:0xf bank_mask:0xf
    v_add_f32_dpp v52, v52, v52 quad_perm:[1,0,3,2] row_mask:0xf bank_mask:0xf
    s_nop 1
    v_add_f32_dpp v48, v48, v48 quad_perm:[2,3,0,1] row_mask:0xf bank_mask:0xf
    v_add_f32_dpp v52, v52, v52 quad_perm:[2,3,0,1] row_mask:0xf bank_mask:0xf
    s_nop 1
    v_add_f32_dpp v48, v48, v48 row_half_mirror row_mask:0xf bank_mask:0xf
    v_add_f32_dpp v52, v52, v52 row_half_mirror row_mask:0xf bank_mask:0xf
    s_nop 1
    v_add_f32_dpp v48, v48, v48 row_mirror row_mask:0xf bank_mask:0xf
    v_add_f32_dpp v52, v52, v52 row_mirror row_mask:0xf bank_mask:0xf
    s_nop 1
    v_add_f32_dpp v48, v48, v48 row_bcast:15 row_mask:0xa bank_mask:0xf
    v_add_f32_dpp v52, v52, v52 row_bcast:15 row_mask:0xa bank_mask:0xf
    s_nop 1
    v_add_f32_dpp v48, v48, v48 row_bcast:31 row_mask:0xc bank_mask:0xf
    v_add_f32_dpp v52, v52, v52 row_bcast:31 row_mask:0xc bank_mask:0xf
    v_mul_f32 v48, 0x3acccccd, v48
    v_mul_f32 v52, 0x3acccccd, v52
    s_nop 0
    v_readlane_b32 s20, v48, 63
    v_readlane_b32 s21, v52, 63
    s_nop 1
    v_subrev_f32 v24, s20, v24
    v_subrev_f32 v25, s20, v25
    v_subrev_f32 v26, s20, v26
    v_subrev_f32 v27, s20, v27
    v_subrev_f32 v28, s20, v28
    v_subrev_f32 v29, s20, v29
    v_subrev_f32 v30, s20, v30
    v_subrev_f32 v31, s20, v31
    v_subrev_f32 v32, s20, v32
    v_subrev_f32 v33, s20, v33
    v_subrev_f32 v36, s21, v36
    v_subrev_f32 v37, s21, v37
    v_subrev_f32 v38, s21, v38
    v_subrev_f32 v39, s21, v39
    v_subrev_f32 v40, s21, v40
    v_subrev_f32 v41, s21, v41
    v_subrev_f32 v42, s21, v42
    v_subrev_f32 v43, s21, v43
    v_subrev_f32 v44, s21, v44
    v_subrev_f32 v45, s21, v45
    v_pk_mul_f32 v[48:49], v[24:25], v[24:25]
    v_pk_fma_f32 v[48:49], v[26:27], v[26:27], v[48:49]
    v_pk_fma_f32 v[48:49], v[28:29], v[28:29], v[48:49]
    v_pk_fma_f32 v[48:49], v[30:31], v[30:31], v[48:49]
    v_pk_fma_f32 v[48:49], v[32:33], v[32:33], v[48:49]
    v_add_f32 v48, v48, v49
    v_pk_mul_f32 v[52:53], v[36:37], v[36:37]
    v_pk_fma_f32 v[52:53], v[38:39], v[38:39], v[52:53]
    v_pk_fma_f32 v[52:53], v[40:41], v[40:41], v[52:53]
    v_pk_fma_f32 v[52:53], v[42:43], v[42:43], v[52:53]
    v_pk_fma_f32 v[52:53], v[44:45], v[44:45], v[52:53]
    v_add_f32 v52, v52, v53
    s_nop 1
    v_add_f32_dpp v48, v48, v48 quad_perm:[1,0,3,2] row_mask:0xf bank_mask:0xf
    v_add_f32_dpp v52, v52, v52 quad_perm:[1,0,3,2] row_mask:0xf bank_mask:0xf
    s_nop 1
    v_add_f32_dpp v48, v48, v48 quad_perm:[2,3,0,1] row_mask:0xf bank_mask:0xf
    v_add_f32_dpp v52, v52, v52 quad_perm:[2,3,0,1] row_mask:0xf bank_mask:0xf
    s_nop 1
    v_add_f32_dpp v48, v48, v48 row_half_mirror row_mask:0xf bank_mask:0xf
    v_add_f32_dpp v52, v52, v52 row_half_mirror row_mask:0xf bank_mask:0xf
    s_nop 1
    v_add_f32_dpp v48, v48, v48 row_mirror row_mask:0xf bank_mask:0xf
    v_add_f32_dpp v52, v52, v52 row_mirror row_mask:0xf bank_mask:0xf
    s_nop 1
    v_add_f32_dpp v48, v48, v48 row_bcast:15 row_mask:0xa bank_mask:0xf
    v_add_f32_dpp v52, v52, v52 row_bcast:15 row_mask:0xa bank_mask:0xf
    s_nop 1
    v_add_f32_dpp v48, v48, v48 row_bcast:31 row_mask:0xc bank_mask:0xf
    v_add_f32_dpp v52, v52, v52 row_bcast:31 row_mask:0xc bank_mask:0xf
    v_mul_f32 v48, 0x3acccccd, v48
    v_mul_f32 v52, 0x3acccccd, v52
    s_nop 0
    v_readlane_b32 s22, v48, 63
    v_readlane_b32 s23, v52, 63
    s_nop 1
    v_mov_b32 v56, s20
    v_mov_b32 v57, s22
    v_writelane_b32 v56, s21, 1
    v_writelane_b32 v57, s23, 1
    s_nop 1
    v_cvt_pk_bf16_f32 v56, v56, v56
    v_lshlrev_b32 v56, 16, v56
    v_cvt_pk_bf16_f32 v57, v57, v57
    v_lshlrev_b32 v57, 16, v57
    v_add_f32 v57, 0x3727c5ac, v57
    v_cvt_pk_bf16_f32 v57, v57, v57
    v_lshlrev_b32 v57, 16, v57
    v_sqrt_f32 v57, v57
    s_nop 0
    v_cvt_pk_bf16_f32 v57, v57, v57
    v_lshlrev_b32 v57, 16, v57
    v_rcp_f32 v60, v57
    s_add_u32 s15, s15, 5324800
    v_lshlrev_b32 v10, 3, v2
    v_add_u32 v10, s15, v10
    v_mul_f32 v61, v56, v60
    v_sub_f32 v61, 0, v61
    s_mov_b64 exec, 3
    global_store_dwordx2 v10, v[60:61], s[12:13] sc1
    s_mov_b64 exec, -1
    s_add_u32 s3, s3, 48
    s_cmp_ge_u32 s3, 128
    s_cbranch_scc1 K01_SDONE
    s_waitcnt vmcnt(2)
    v_lshlrev_b32 v24, 16, v88
    v_and_b32 v25, 0xffff0000, v88
    v_lshlrev_b32 v26, 16, v89
    v_and_b32 v27, 0xffff0000, v89
    v_lshlrev_b32 v28, 16, v90
    v_and_b32 v29, 0xffff0000, v90
    v_lshlrev_b32 v30, 16, v91
    v_and_b32 v31, 0xffff0000, v91
    v_lshlrev_b32 v32, 16, v92
    v_and_b32 v33, 0xffff0000, v92
    v_lshlrev_b32 v36, 16, v94
    v_and_b32 v37, 0xffff0000, v94
    v_lshlrev_b32 v38, 16, v95
    v_and_b32 v39, 0xffff0000, v95
    v_lshlrev_b32 v40, 16, v96
    v_and_b32 v41, 0xffff0000, v96
    v_lshlrev_b32 v42, 16, v97
    v_and_b32 v43, 0xffff0000, v97
    v_lshlrev_b32 v44, 16, v98
    v_and_b32 v45, 0xffff0000, v98
    s_lshl_b32 s15, s44, 4
    s_add_u32 s15, s15, 12288
    v_pk_add_f32 v[48:49], v[24:25], v[26:27]
    v_pk_add_f32 v[50:51], v[28:29], v[30:31]
    v_pk_add_f32 v[48:49], v[48:49], v[32:33]
    v_pk_add_f32 v[48:49], v[48:49], v[50:51]
    v_add_f32 v48, v48, v49
    v_pk_add_f32 v[52:53], v[36:37], v[38:39]
    v_pk_add_f32 v[54:55], v[40:41], v[42:43]
    v_pk_add_f32 v[52:53], v[52:53], v[44:45]
    v_pk_add_f32 v[52:53], v[52:53], v[54:55]
    v_add_f32 v52, v52, v53
    s_nop 1
    v_add_f32_dpp v48, v48, v48 quad_perm:[1,0,3,2] row_mask:0xf bank_mask:0xf
    v_add_f32_dpp v52, v52, v52 quad_perm:[1,0,3,2] row_mask:0xf bank_mask:0xf
    s_nop 1
    v_add_f32_dpp v48, v48, v48 quad_perm:[2,3,0,1] row_mask:0xf bank_mask:0xf
    v_add_f32_dpp v52, v52, v52 quad_perm:[2,3,0,1] row_mask:0xf bank_mask:0xf
    s_nop 1
    v_add_f32_dpp v48, v48, v48 row_half_mirror row_mask:0xf bank_mask:0xf
    v_add_f32_dpp v52, v52, v52 row_half_mirror row_mask:0xf bank_mask:0xf
    s_nop 1
    v_add_f32_dpp v48, v48, v48 row_mirror row_mask:0xf bank_mask:0xf
    v_add_f32_dpp v52, v52, v52 row_mirror row_mask:0xf bank_mask:0xf
    s_nop 1
    v_add_f32_dpp v48, v48, v48 row_bcast:15 row_mask:0xa bank_mask:0xf
    v_add_f32_dpp v52, v52, v52 row_bcast:15 row_mask:0xa bank_mask:0xf
    s_nop 1
    v_add_f32_dpp v48, v48, v48 row_bcast:31 row_mask:0xc bank_mask:0xf
    v_add_f32_dpp v52, v52, v52 row_bcast:31 row_mask:0xc bank_mask:0xf
    v_mul_f32 v48, 0x3acccccd, v48
    v_mul_f32 v52, 0x3acccccd, v52
    s_nop 0
    v_readlane_b32 s20, v48, 63
    v_readlane_b32 s21, v52, 63
    s_nop 1
    v_subrev_f32 v24, s20, v24
    v_subrev_f32 v25, s20, v25
    v_subrev_f32 v26, s20, v26
    v_subrev_f32 v27, s20, v27
    v_subrev_f32 v28, s20, v28
    v_subrev_f32 v29, s20, v29
    v_subrev_f32 v30, s20, v30
    v_subrev_f32 v31, s20, v31
    v_subrev_f32 v32, s20, v32
    v_subrev_f32 v33, s20, v33
    v_subrev_f32 v36, s21, v36
    v_subrev_f32 v37, s21, v37
    v_subrev_f32 v38, s21, v38
    v_subrev_f32 v39, s21, v39
    v_subrev_f32 v40, s21, v40
    v_subrev_f32 v41, s21, v41
    v_subrev_f32 v42, s21, v42
    v_subrev_f32 v43, s21, v43
    v_subrev_f32 v44, s21, v44
    v_subrev_f32 v45, s21, v45
    v_pk_mul_f32 v[48:49], v[24:25], v[24:25]
    v_pk_fma_f32 v[48:49], v[26:27], v[26:27], v[48:49]
    v_pk_fma_f32 v[48:49], v[28:29], v[28:29], v[48:49]
    v_pk_fma_f32 v[48:49], v[30:31], v[30:31], v[48:49]
    v_pk_fma_f32 v[48:49], v[32:33], v[32:33], v[48:49]
    v_add_f32 v48, v48, v49
    v_pk_mul_f32 v[52:53], v[36:37], v[36:37]
    v_pk_fma_f32 v[52:53], v[38:39], v[38:39], v[52:53]
    v_pk_fma_f32 v[52:53], v[40:41], v[40:41], v[52:53]
    v_pk_fma_f32 v[52:53], v[42:43], v[42:43], v[52:53]
    v_pk_fma_f32 v[52:53], v[44:45], v[44:45], v[52:53]
    v_add_f32 v52, v52, v53
    s_nop 1
    v_add_f32_dpp v48, v48, v48 quad_perm:[1,0,3,2] row_mask:0xf bank_mask:0xf
    v_add_f32_dpp v52, v52, v52 quad_perm:[1,0,3,2] row_mask:0xf bank_mask:0xf
    s_nop 1
    v_add_f32_dpp v48, v48, v48 quad_perm:[2,3,0,1] row_mask:0xf bank_mask:0xf
    v_add_f32_dpp v52, v52, v52 quad_perm:[2,3,0,1] row_mask:0xf bank_mask:0xf
    s_nop 1
    v_add_f32_dpp v48, v48, v48 row_half_mirror row_mask:0xf bank_mask:0xf
    v_add_f32_dpp v52, v52, v52 row_half_mirror row_mask:0xf bank_mask:0xf
    s_nop 1
    v_add_f32_dpp v48, v48, v48 row_mirror row_mask:0xf bank_mask:0xf
    v_add_f32_dpp v52, v52, v52 row_mirror row_mask:0xf bank_mask:0xf
    s_nop 1
    v_add_f32_dpp v48, v48, v48 row_bcast:15 row_mask:0xa bank_mask:0xf
    v_add_f32_dpp v52, v52, v52 row_bcast:15 row_mask:0xa bank_mask:0xf
    s_nop 1
    v_add_f32_dpp v48, v48, v48 row_bcast:31 row_mask:0xc bank_mask:0xf
    v_add_f32_dpp v52, v52, v52 row_bcast:31 row_mask:0xc bank_mask:0xf
    v_mul_f32 v48, 0x3acccccd, v48
    v_mul_f32 v52, 0x3acccccd, v52
    s_nop 0
    v_readlane_b32 s22, v48, 63
    v_readlane_b32 s23, v52, 63
    s_nop 1
    v_mov_b32 v56, s20
    v_mov_b32 v57, s22
    v_writelane_b32 v56, s21, 1
    v_writelane_b32 v57, s23, 1
    s_nop 1
    v_cvt_pk_bf16_f32 v56, v56, v56
    v_lshlrev_b32 v56, 16, v56
    v_cvt_pk_bf16_f32 v57, v57, v57
    v_lshlrev_b32 v57, 16, v57
    v_add_f32 v57, 0x3727c5ac, v57
    v_cvt_pk_bf16_f32 v57, v57, v57
    v_lshlrev_b32 v57, 16, v57
    v_sqrt_f32 v57, v57
    s_nop 0
    v_cvt_pk_bf16_f32 v57, v57, v57
    v_lshlrev_b32 v57, 16, v57
    v_rcp_f32 v58, v57
    s_add_u32 s15, s15, 5324800
    v_lshlrev_b32 v10, 3, v2
    v_add_u32 v10, s15, v10
    v_mul_f32 v59, v56, v58
    v_sub_f32 v59, 0, v59
    s_mov_b64 exec, 3
    global_store_dwordx2 v10, v[58:59], s[12:13] sc1
    s_mov_b64 exec, -1
    s_add_u32 s3, s3, 48
K01_SDONE:
    v_lshlrev_b32 v160, 7, v2
    v_add_u32 v160, 20507136, v160
    v_mov_b32 v161, 1
    s_waitcnt vmcnt(0)
    s_barrier
    s_cmp_lg_u32 s14, 4
    s_cbranch_scc1 SSIG_S
    s_mov_b32 s35, 400000
SPIN_SR3:
    buffer_load_dword v7, v8, s[40:43], 0 offen sc1
    s_waitcnt vmcnt(0)
    v_cmp_le_u32 vcc, 1, v7
    s_nop 1
    s_cmp_eq_u64 vcc, -1
    s_cbranch_scc1 SPUN_SR3
    s_sleep 4
    s_sub_u32 s35, s35, 1
    s_cmp_lg_u32 s35, 0
    s_cbranch_scc1 SPIN_SR3
SPUN_SR3:
    s_mov_b64 exec, 0xff
    buffer_atomic_add v161, v160, s[36:39], 0 offen
    s_mov_b64 exec, -1
SSIG_S:
    s_cmp_ge_u32 s14, 4
    s_cbranch_scc1 K34_JOIN
    s_branch K01_PBACK
K1_PACK:
    s_load_dwordx4 s[4:7], s[0:1], 56
    s_load_dwordx2 s[8:9], s[0:1], 72
    s_load_dwordx2 s[12:13], s[0:1], 96
    v_lshrrev_b32 v1, 6, v0
    v_and_b32 v2, 63, v0
    v_readfirstlane_b32 s14, v1
    s_mov_b32 s30, 0x05040100
    s_mov_b32 s31, 0x07060302
    s_branch K01_STATS
K01_PBACK:
    s_cmp_ge_u32 s2, 208
    s_cbranch_scc1 K1_PACK2
    s_sub_u32 s16, s2, 160
    s_lshr_b32 s16, s16, 3
    s_lshl_b32 s16, s16, 1
    s_and_b32 s17, s2, 1
    s_add_u32 s16, s16, s17
    s_cmp_ge_u32 s16, 6
    s_cselect_b32 s15, 1, 0
    s_mul_i32 s17, s15, 6
    s_sub_u32 s16, s16, s17
    s_bfe_u32 s3, s2, 0x20001
    s_mul_i32 s3, s3, 6
    s_add_u32 s3, s3, s16
    v_lshrrev_b32 v3, 5, v2
    v_and_b32 v4, 31, v2
    s_movk_i32 s17, 12288
    v_mul_u32_u24 v5, s17, v3
    v_lshl_add_u32 v5, v4, 2, v5
    s_and_b32 s44, s14, 3
    s_lshr_b32 s45, s14, 2
    s_lshl_b32 s16, s3, 7
    s_mul_i32 s17, s44, 491520
    s_add_u32 s16, s16, s17
    s_mul_i32 s17, s45, 24576
    s_add_u32 s16, s16, s17
    v_add_u32 v5, s16, v5
    s_waitcnt lgkmcnt(0)
    s_cmp_eq_u32 s15, 1
    s_cselect_b32 s16, s6, s4
    s_cselect_b32 s17, s7, s5
    s_mov_b32 s18, 1966080
    s_mov_b32 s19, 0x20000
    s_mov_b32 s21, 3072
    s_mov_b32 s22, 6144
    s_mov_b32 s23, 9216
    s_mov_b32 s24, 49152
    s_mov_b32 s25, 52224
    s_mov_b32 s26, 55296
    s_mov_b32 s27, 58368
    buffer_load_dword v32, v5, s[16:19], 0 offen
    buffer_load_dword v33, v5, s[16:19], s21 offen
    buffer_load_dword v34, v5, s[16:19], s22 offen
    buffer_load_dword v35, v5, s[16:19], s23 offen
    buffer_load_dword v36, v5, s[16:19], s24 offen
    buffer_load_dword v37, v5, s[16:19], s25 offen
    buffer_load_dword v38, v5, s[16:19], s26 offen
    buffer_load_dword v39, v5, s[16:19], s27 offen
    v_add_u32 v5, 98304, v5
    buffer_load_dword v40, v5, s[16:19], 0 offen
    buffer_load_dword v41, v5, s[16:19], s21 offen
    buffer_load_dword v42, v5, s[16:19], s22 offen
    buffer_load_dword v43, v5, s[16:19], s23 offen
    buffer_load_dword v44, v5, s[16:19], s24 offen
    buffer_load_dword v45, v5, s[16:19], s25 offen
    buffer_load_dword v46, v5, s[16:19], s26 offen
    buffer_load_dword v47, v5, s[16:19], s27 offen
    v_add_u32 v5, 98304, v5
    buffer_load_dword v48, v5, s[16:19], 0 offen
    buffer_load_dword v49, v5, s[16:19], s21 offen
    buffer_load_dword v50, v5, s[16:19], s22 offen
    buffer_load_dword v51, v5, s[16:19], s23 offen
    buffer_load_dword v52, v5, s[16:19], s24 offen
    buffer_load_dword v53, v5, s[16:19], s25 offen
    buffer_load_dword v54, v5, s[16:19], s26 offen
    buffer_load_dword v55, v5, s[16:19], s27 offen
    v_add_u32 v5, 98304, v5
    buffer_load_dword v56, v5, s[16:19], 0 offen
    buffer_load_dword v57, v5, s[16:19], s21 offen
    buffer_load_dword v58, v5, s[16:19], s22 offen
    buffer_load_dword v59, v5, s[16:19], s23 offen
    buffer_load_dword v60, v5, s[16:19], s24 offen
    buffer_load_dword v61, v5, s[16:19], s25 offen
    buffer_load_dword v62, v5, s[16:19], s26 offen
    buffer_load_dword v63, v5, s[16:19], s27 offen
    v_add_u32 v5, 98304, v5
    buffer_load_dword v64, v5, s[16:19], 0 offen
    buffer_load_dword v65, v5, s[16:19], s21 offen
    buffer_load_dword v66, v5, s[16:19], s22 offen
    buffer_load_dword v67, v5, s[16:19], s23 offen
    buffer_load_dword v68, v5, s[16:19], s24 offen
    buffer_load_dword v69, v5, s[16:19], s25 offen
    buffer_load_dword v70, v5, s[16:19], s26 offen
    buffer_load_dword v71, v5, s[16:19], s27 offen
    s_lshl_b32 s28, s3, 2
    v_lshrrev_b32 v8, 3, v4
    v_add_u32 v8, s28, v8
    v_mul_u32_u24 v9, 43, v8
    v_lshrrev_b32 v9, 8, v9
    v_mul_u32_u24 v11, 6, v9
    v_sub_u32 v11, v8, v11
    v_lshlrev_b32 v11, 2, v11
    s_mov_b32 s28, 0x435210
    v_lshrrev_b32 v11, v11, s28
    v_and_b32 v11, 7, v11
    v_lshlrev_b32 v11, 11, v11
    s_mov_b32 s28, 258048
    v_mul_lo_u32 v9, v9, s28
    v_add_u32 v11, v11, v9
    v_and_b32 v12, 7, v4
    v_lshl_add_u32 v11, v12, 5, v11
    v_lshl_add_u32 v11, v3, 8, v11
    s_lshl_b32 s28, s15, 10
    s_mul_i32 s29, s44, 61440
    s_add_u32 s28, s28, s29
    s_lshl_b32 s29, s45, 9
    s_add_u32 s28, s28, s29
    s_add_u32 s28, s28, 8093696
    v_add_u32 v11, s28, v11
    v_mov_b32 v15, 0x3f803f80
    v_mov_b32 v16, 0
    v_mov_b32 v17, 0
    v_and_b32 v20, 7, v2
    v_lshlrev_b32 v20, 6, v20
    v_sub_u32 v20, 224, v20
    v_and_b32 v21, 4, v2
    v_cmp_ne_u32 s[46:47], 0, v21
    v_add_u32 v21, 16, v20
    v_mov_b32 v22, 16
    v_cndmask_b32 v18, 0, v21, s[46:47]
    v_cndmask_b32 v19, v20, v22, s[46:47]
    v_add_u32 v18, v18, v11
    v_add_u32 v19, v19, v11
    s_waitcnt vmcnt(32)
    v_perm_b32 v112, v33, v32, s30
    v_perm_b32 v113, v35, v34, s30
    v_perm_b32 v114, v37, v36, s30
    v_perm_b32 v115, v39, v38, s30
    v_perm_b32 v116, v33, v32, s31
    v_perm_b32 v117, v35, v34, s31
    v_perm_b32 v118, v37, v36, s31
    v_perm_b32 v119, v39, v38, s31
    v_cndmask_b32 v128, v116, v112, s[46:47]
    v_cndmask_b32 v129, v117, v113, s[46:47]
    v_cndmask_b32 v130, v118, v114, s[46:47]
    v_cndmask_b32 v131, v119, v115, s[46:47]
    v_mov_b32_dpp v128, v128 row_half_mirror row_mask:0xf bank_mask:0xf
    v_mov_b32_dpp v129, v129 row_half_mirror row_mask:0xf bank_mask:0xf
    v_mov_b32_dpp v130, v130 row_half_mirror row_mask:0xf bank_mask:0xf
    v_mov_b32_dpp v131, v131 row_half_mirror row_mask:0xf bank_mask:0xf
    v_cndmask_b32 v132, v112, v128, s[46:47]
    v_cndmask_b32 v133, v113, v129, s[46:47]
    v_cndmask_b32 v134, v114, v130, s[46:47]
    v_cndmask_b32 v135, v115, v131, s[46:47]
    global_store_dwordx4 v18, v[132:135], s[12:13] offset:0 sc1
    v_cndmask_b32 v136, v128, v116, s[46:47]
    v_cndmask_b32 v137, v129, v117, s[46:47]
    v_cndmask_b32 v138, v130, v118, s[46:47]
    v_cndmask_b32 v139, v131, v119, s[46:47]
    global_store_dwordx4 v19, v[136:139], s[12:13] offset:0 sc1
    v_dot2c_f32_bf16 v16, v112, v15
    v_dot2c_f32_bf16 v17, v116, v15
    v_dot2c_f32_bf16 v16, v113, v15
    v_dot2c_f32_bf16 v17, v117, v15
    v_dot2c_f32_bf16 v16, v114, v15
    v_dot2c_f32_bf16 v17, v118, v15
    v_dot2c_f32_bf16 v16, v115, v15
    v_dot2c_f32_bf16 v17, v119, v15
    s_waitcnt vmcnt(26)
    v_add_u32 v11, 12288, v11
    v_add_u32 v18, 12288, v18
    v_add_u32 v19, 12288, v19
    v_perm_b32 v120, v41, v40, s30
    v_perm_b32 v121, v43, v42, s30
    v_perm_b32 v122, v45, v44, s30
    v_perm_b32 v123, v47, v46, s30
    v_perm_b32 v124, v41, v40, s31
    v_perm_b32 v125, v43, v42, s31
    v_perm_b32 v126, v45, v44, s31
    v_perm_b32 v127, v47, v46, s31
    v_cndmask_b32 v140, v124, v120, s[46:47]
    v_cndmask_b32 v141, v125, v121, s[46:47]
    v_cndmask_b32 v142, v126, v122, s[46:47]
    v_cndmask_b32 v143, v127, v123, s[46:47]
    v_mov_b32_dpp v140, v140 row_half_mirror row_mask:0xf bank_mask:0xf
    v_mov_b32_dpp v141, v141 row_half_mirror row_mask:0xf bank_mask:0xf
    v_mov_b32_dpp v142, v142 row_half_mirror row_mask:0xf bank_mask:0xf
    v_mov_b32_dpp v143, v143 row_half_mirror row_mask:0xf bank_mask:0xf
    v_cndmask_b32 v144, v120, v140, s[46:47]
    v_cndmask_b32 v145, v121, v141, s[46:47]
    v_cndmask_b32 v146, v122, v142, s[46:47]
    v_cndmask_b32 v147, v123, v143, s[46:47]
    global_store_dwordx4 v18, v[144:147], s[12:13] offset:0 sc1
    v_cndmask_b32 v148, v140, v124, s[46:47]
    v_cndmask_b32 v149, v141, v125, s[46:47]
    v_cndmask_b32 v150, v142, v126, s[46:47]
    v_cndmask_b32 v151, v143, v127, s[46:47]
    global_store_dwordx4 v19, v[148:151], s[12:13] offset:0 sc1
    v_dot2c_f32_bf16 v16, v120, v15
    v_dot2c_f32_bf16 v17, v124, v15
    v_dot2c_f32_bf16 v16, v121, v15
    v_dot2c_f32_bf16 v17, v125, v15
    v_dot2c_f32_bf16 v16, v122, v15
    v_dot2c_f32_bf16 v17, v126, v15
    v_dot2c_f32_bf16 v16, v123, v15
    v_dot2c_f32_bf16 v17, v127, v15
    s_waitcnt vmcnt(20)
    v_add_u32 v11, 12288, v11
    v_add_u32 v18, 12288, v18
    v_add_u32 v19, 12288, v19
    v_perm_b32 v112, v49, v48, s30
    v_perm_b32 v113, v51, v50, s30
    v_perm_b32 v114, v53, v52, s30
    v_perm_b32 v115, v55, v54, s30
    v_perm_b32 v116, v49, v48, s31
    v_perm_b32 v117, v51, v50, s31
    v_perm_b32 v118, v53, v52, s31
    v_perm_b32 v119, v55, v54, s31
    v_cndmask_b32 v128, v116, v112, s[46:47]
    v_cndmask_b32 v129, v117, v113, s[46:47]
    v_cndmask_b32 v130, v118, v114, s[46:47]
    v_cndmask_b32 v131, v119, v115, s[46:47]
    v_mov_b32_dpp v128, v128 row_half_mirror row_mask:0xf bank_mask:0xf
    v_mov_b32_dpp v129, v129 row_half_mirror row_mask:0xf bank_mask:0xf
    v_mov_b32_dpp v130, v130 row_half_mirror row_mask:0xf bank_mask:0xf
    v_mov_b32_dpp v131, v131 row_half_mirror row_mask:0xf bank_mask:0xf
    v_cndmask_b32 v132, v112, v128, s[46:47]
    v_cndmask_b32 v133, v113, v129, s[46:47]
    v_cndmask_b32 v134, v114, v130, s[46:47]
    v_cndmask_b32 v135, v115, v131, s[46:47]
    global_store_dwordx4 v18, v[132:135], s[12:13] offset:0 sc1
    v_cndmask_b32 v136, v128, v116, s[46:47]
    v_cndmask_b32 v137, v129, v117, s[46:47]
    v_cndmask_b32 v138, v130, v118, s[46:47]
    v_cndmask_b32 v139, v131, v119, s[46:47]
    global_store_dwordx4 v19, v[136:139], s[12:13] offset:0 sc1
    v_dot2c_f32_bf16 v16, v112, v15
    v_dot2c_f32_bf16 v17, v116, v15
    v_dot2c_f32_bf16 v16, v113, v15
    v_dot2c_f32_bf16 v17, v117, v15
    v_dot2c_f32_bf16 v16, v114, v15
    v_dot2c_f32_bf16 v17, v118, v15
    v_dot2c_f32_bf16 v16, v115, v15
    v_dot2c_f32_bf16 v17, v119, v15
    s_waitcnt vmcnt(14)
    v_add_u32 v11, 12288, v11
    v_add_u32 v18, 12288, v18
    v_add_u32 v19, 12288, v19
    v_perm_b32 v120, v57, v56, s30
    v_perm_b32 v121, v59, v58, s30
    v_perm_b32 v122, v61, v60, s30
    v_perm_b32 v123, v63, v62, s30
    v_perm_b32 v124, v57, v56, s31
    v_perm_b32 v125, v59, v58, s31
    v_perm_b32 v126, v61, v60, s31
    v_perm_b32 v127, v63, v62, s31
    v_cndmask_b32 v140, v124, v120, s[46:47]
    v_cndmask_b32 v141, v125, v121, s[46:47]
    v_cndmask_b32 v142, v126, v122, s[46:47]
    v_cndmask_b32 v143, v127, v123, s[46:47]
    v_mov_b32_dpp v140, v140 row_half_mirror row_mask:0xf bank_mask:0xf
    v_mov_b32_dpp v141, v141 row_half_mirror row_mask:0xf bank_mask:0xf
    v_mov_b32_dpp v142, v142 row_half_mirror row_mask:0xf bank_mask:0xf
    v_mov_b32_dpp v143, v143 row_half_mirror row_mask:0xf bank_mask:0xf
    v_cndmask_b32 v144, v120, v140, s[46:47]
    v_cndmask_b32 v145, v121, v141, s[46:47]
    v_cndmask_b32 v146, v122, v142, s[46:47]
    v_cndmask_b32 v147, v123, v143, s[46:47]
    global_store_dwordx4 v18, v[144:147], s[12:13] offset:0 sc1
    v_cndmask_b32 v148, v140, v124, s[46:47]
    v_cndmask_b32 v149, v141, v125, s[46:47]
    v_cndmask_b32 v150, v142, v126, s[46:47]
    v_cndmask_b32 v151, v143, v127, s[46:47]
    global_store_dwordx4 v19, v[148:151], s[12:13] offset:0 sc1
    v_dot2c_f32_bf16 v16, v120, v15
    v_dot2c_f32_bf16 v17, v124, v15
    v_dot2c_f32_bf16 v16, v121, v15
    v_dot2c_f32_bf16 v17, v125, v15
    v_dot2c_f32_bf16 v16, v122, v15
    v_dot2c_f32_bf16 v17, v126, v15
    v_dot2c_f32_bf16 v16, v123, v15
    v_dot2c_f32_bf16 v17, v127, v15
    s_waitcnt vmcnt(8)
    v_add_u32 v11, 12288, v11
    v_add_u32 v18, 12288, v18
    v_add_u32 v19, 12288, v19
    v_perm_b32 v112, v65, v64, s30
    v_perm_b32 v113, v67, v66, s30
    v_perm_b32 v114, v69, v68, s30
    v_perm_b32 v115, v71, v70, s30
    v_perm_b32 v116, v65, v64, s31
    v_perm_b32 v117, v67, v66, s31
    v_perm_b32 v118, v69, v68, s31
    v_perm_b32 v119, v71, v70, s31
    v_cndmask_b32 v128, v116, v112, s[46:47]
    v_cndmask_b32 v129, v117, v113, s[46:47]
    v_cndmask_b32 v130, v118, v114, s[46:47]
    v_cndmask_b32 v131, v119, v115, s[46:47]
    v_mov_b32_dpp v128, v128 row_half_mirror row_mask:0xf bank_mask:0xf
    v_mov_b32_dpp v129, v129 row_half_mirror row_mask:0xf bank_mask:0xf
    v_mov_b32_dpp v130, v130 row_half_mirror row_mask:0xf bank_mask:0xf
    v_mov_b32_dpp v131, v131 row_half_mirror row_mask:0xf bank_mask:0xf
    v_cndmask_b32 v132, v112, v128, s[46:47]
    v_cndmask_b32 v133, v113, v129, s[46:47]
    v_cndmask_b32 v134, v114, v130, s[46:47]
    v_cndmask_b32 v135, v115, v131, s[46:47]
    global_store_dwordx4 v18, v[132:135], s[12:13] offset:0 sc1
    v_cndmask_b32 v136, v128, v116, s[46:47]
    v_cndmask_b32 v137, v129, v117, s[46:47]
    v_cndmask_b32 v138, v130, v118, s[46:47]
    v_cndmask_b32 v139, v131, v119, s[46:47]
    global_store_dwordx4 v19, v[136:139], s[12:13] offset:0 sc1
    v_dot2c_f32_bf16 v16, v112, v15
    v_dot2c_f32_bf16 v17, v116, v15
    v_dot2c_f32_bf16 v16, v113, v15
    v_dot2c_f32_bf16 v17, v117, v15
    v_dot2c_f32_bf16 v16, v114, v15
    v_dot2c_f32_bf16 v17, v118, v15
    v_dot2c_f32_bf16 v16, v115, v15
    v_dot2c_f32_bf16 v17, v119, v15
    v_lshlrev_b32 v24, 3, v0
    s_nop 2
    ds_write_b64 v24, v[16:17]
    s_waitcnt lgkmcnt(0)
    s_barrier
    s_cmp_lg_u32 s14, 0
    s_cbranch_scc1 K1_P2END
    v_lshlrev_b32 v24, 2, v2
    ds_read_b32 v32, v24 offset:0
    ds_read_b32 v33, v24 offset:256
    ds_read_b32 v34, v24 offset:512
    ds_read_b32 v35, v24 offset:768
    ds_read_b32 v36, v24 offset:1024
    ds_read_b32 v37, v24 offset:1280
    ds_read_b32 v38, v24 offset:1536
    ds_read_b32 v39, v24 offset:1792
    ds_read_b32 v40, v24 offset:2048
    ds_read_b32 v41, v24 offset:2304
    ds_read_b32 v42, v24 offset:2560
    ds_read_b32 v43, v24 offset:2816
    ds_read_b32 v44, v24 offset:3072
    ds_read_b32 v45, v24 offset:3328
    ds_read_b32 v46, v24 offset:3584
    ds_read_b32 v47, v24 offset:3840
    s_waitcnt lgkmcnt(0)
    v_add_f32 v32, v32, v40
    v_add_f32 v33, v33, v41
    v_add_f32 v34, v34, v42
    v_add_f32 v35, v35, v43
    v_add_f32 v36, v36, v44
    v_add_f32 v37, v37, v45
    v_add_f32 v38, v38, v46
    v_add_f32 v39, v39, v47
    v_add_f32 v32, v32, v36
    v_add_f32 v33, v33, v37
    v_add_f32 v34, v34, v38
    v_add_f32 v35, v35, v39
    v_add_f32 v32, v32, v34
    v_add_f32 v33, v33, v35
    v_add_f32 v32, v32, v33
    v_cvt_pk_bf16_f32 v33, v32, v32
    v_lshlrev_b32 v34, 16, v33
    v_sub_f32 v35, v32, v34
    v_cvt_pk_bf16_f32 v36, v35, v35
    v_lshlrev_b32 v37, 16, v36
    v_sub_f32 v35, v35, v37
    v_cvt_pk_bf16_f32 v38, v35, v35
    v_and_b32 v33, 0xffff, v33
    v_or_b32 v40, v33, v37
    v_and_b32 v41, 0xffff, v38
    v_mov_b32 v42, 0
    v_mov_b32 v43, 0
    v_mov_b32 v44, 0
    v_mov_b32 v45, 0
    v_mov_b32 v46, 0
    v_mov_b32 v47, 0
    s_lshl_b32 s28, s3, 2
    v_lshrrev_b32 v8, 4, v2
    v_add_u32 v8, s28, v8
    v_mul_u32_u24 v9, 43, v8
    v_lshrrev_b32 v9, 8, v9
    v_mul_u32_u24 v11, 6, v9
    v_sub_u32 v11, v8, v11
    v_lshlrev_b32 v11, 2, v11
    s_mov_b32 s28, 0x435210
    v_lshrrev_b32 v11, v11, s28
    v_and_b32 v11, 7, v11
    v_lshlrev_b32 v11, 11, v11
    s_mov_b32 s28, 258048
    v_mul_lo_u32 v9, v9, s28
    v_add_u32 v11, v11, v9
    v_and_b32 v12, 15, v2
    v_lshl_add_u32 v11, v12, 4, v11
    s_lshl_b32 s28, s15, 10
    s_add_u32 s28, s28, 8339456
    v_add_u32 v11, s28, v11
    global_store_dwordx4 v11, v[40:43], s[12:13] sc1
    global_store_dwordx4 v11, v[44:47], s[12:13] offset:256 sc1
    global_store_dwordx4 v11, v[44:47], s[12:13] offset:512 sc1
    global_store_dwordx4 v11, v[44:47], s[12:13] offset:768 sc1
    s_branch K1_P2END
K1_PACK2:
    s_sub_u32 s3, s2, 208
    s_lshl_b32 s15, s3, 5
    s_lshl_b32 s16, s14, 2
    s_add_u32 s15, s15, s16
    s_mul_i32 s15, s15, 1280
    v_lshlrev_b32 v3, 2, v2
    v_add_u32 v3, s15, v3
    v_add_u32 v4, 20480, v3
    s_waitcnt lgkmcnt(0)
    global_load_dword v32, v3, s[8:9] offset:0
    global_load_dword v33, v3, s[8:9] offset:1280
    global_load_dword v34, v3, s[8:9] offset:2560
    global_load_dword v35, v3, s[8:9] offset:3840
    global_load_dword v36, v4, s[8:9] offset:0
    global_load_dword v37, v4, s[8:9] offset:1280
    global_load_dword v38, v4, s[8:9] offset:2560
    global_load_dword v39, v4, s[8:9] offset:3840
    v_add_u32 v3, 256, v3
    v_add_u32 v4, 256, v4
    global_load_dword v40, v3, s[8:9] offset:0
    global_load_dword v41, v3, s[8:9] offset:1280
    global_load_dword v42, v3, s[8:9] offset:2560
    global_load_dword v43, v3, s[8:9] offset:3840
    global_load_dword v44, v4, s[8:9] offset:0
    global_load_dword v45, v4, s[8:9] offset:1280
    global_load_dword v46, v4, s[8:9] offset:2560
    global_load_dword v47, v4, s[8:9] offset:3840
    v_add_u32 v3, 256, v3
    v_add_u32 v4, 256, v4
    global_load_dword v48, v3, s[8:9] offset:0
    global_load_dword v49, v3, s[8:9] offset:1280
    global_load_dword v50, v3, s[8:9] offset:2560
    global_load_dword v51, v3, s[8:9] offset:3840
    global_load_dword v52, v4, s[8:9] offset:0
    global_load_dword v53, v4, s[8:9] offset:1280
    global_load_dword v54, v4, s[8:9] offset:2560
    global_load_dword v55, v4, s[8:9] offset:3840
    v_add_u32 v3, 256, v3
    v_add_u32 v4, 256, v4
    global_load_dword v56, v3, s[8:9] offset:0
    global_load_dword v57, v3, s[8:9] offset:1280
    global_load_dword v58, v3, s[8:9] offset:2560
    global_load_dword v59, v3, s[8:9] offset:3840
    global_load_dword v60, v4, s[8:9] offset:0
    global_load_dword v61, v4, s[8:9] offset:1280
    global_load_dword v62, v4, s[8:9] offset:2560
    global_load_dword v63, v4, s[8:9] offset:3840
    v_add_u32 v3, 256, v3
    v_add_u32 v4, 256, v4
    global_load_dword v64, v3, s[8:9] offset:0
    global_load_dword v65, v3, s[8:9] offset:1280
    global_load_dword v66, v3, s[8:9] offset:2560
    global_load_dword v67, v3, s[8:9] offset:3840
    global_load_dword v68, v4, s[8:9] offset:0
    global_load_dword v69, v4, s[8:9] offset:1280
    global_load_dword v70, v4, s[8:9] offset:2560
    global_load_dword v71, v4, s[8:9] offset:3840
    v_lshrrev_b32 v10, 3, v2
    v_and_b32 v9, 7, v2
    v_lshlrev_b32 v9, 5, v9
    s_mul_i32 s20, s3, 5120
    s_lshl_b32 s21, s14, 8
    s_add_u32 s20, s20, s21
    s_add_u32 s20, s20, 12222464
    v_add_u32 v9, s20, v9
    s_mov_b32 s20, 240640
    v_and_b32 v20, 7, v2
    v_lshlrev_b32 v20, 6, v20
    v_sub_u32 v20, 224, v20
    v_and_b32 v21, 4, v2
    v_cmp_ne_u32 s[46:47], 0, v21
    v_add_u32 v21, 16, v20
    v_mov_b32 v22, 16
    v_cndmask_b32 v18, 0, v21, s[46:47]
    v_cndmask_b32 v19, v20, v22, s[46:47]
    s_waitcnt vmcnt(32)
    v_add_u32 v11, 0, v10
    v_mul_u32_u24 v12, 52, v11
    v_lshrrev_b32 v12, 8, v12
    v_lshl_add_u32 v8, v11, 10, v9
    v_mad_u32_u24 v8, v12, s20, v8
    v_perm_b32 v112, v33, v32, s30
    v_perm_b32 v113, v35, v34, s30
    v_perm_b32 v114, v37, v36, s30
    v_perm_b32 v115, v39, v38, s30
    v_perm_b32 v116, v33, v32, s31
    v_perm_b32 v117, v35, v34, s31
    v_perm_b32 v118, v37, v36, s31
    v_perm_b32 v119, v39, v38, s31
    v_add_u32 v13, v18, v8
    v_add_u32 v14, v19, v8
    v_cndmask_b32 v128, v116, v112, s[46:47]
    v_cndmask_b32 v129, v117, v113, s[46:47]
    v_cndmask_b32 v130, v118, v114, s[46:47]
    v_cndmask_b32 v131, v119, v115, s[46:47]
    v_mov_b32_dpp v128, v128 row_half_mirror row_mask:0xf bank_mask:0xf
    v_mov_b32_dpp v129, v129 row_half_mirror row_mask:0xf bank_mask:0xf
    v_mov_b32_dpp v130, v130 row_half_mirror row_mask:0xf bank_mask:0xf
    v_mov_b32_dpp v131, v131 row_half_mirror row_mask:0xf bank_mask:0xf
    v_cndmask_b32 v132, v112, v128, s[46:47]
    v_cndmask_b32 v133, v113, v129, s[46:47]
    v_cndmask_b32 v134, v114, v130, s[46:47]
    v_cndmask_b32 v135, v115, v131, s[46:47]
    global_store_dwordx4 v13, v[132:135], s[12:13] offset:0 sc1
    v_cndmask_b32 v136, v128, v116, s[46:47]
    v_cndmask_b32 v137, v129, v117, s[46:47]
    v_cndmask_b32 v138, v130, v118, s[46:47]
    v_cndmask_b32 v139, v131, v119, s[46:47]
    global_store_dwordx4 v14, v[136:139], s[12:13] offset:0 sc1
    s_waitcnt vmcnt(26)
    v_add_u32 v11, 8, v10
    v_mul_u32_u24 v12, 52, v11
    v_lshrrev_b32 v12, 8, v12
    v_lshl_add_u32 v8, v11, 10, v9
    v_mad_u32_u24 v8, v12, s20, v8
    v_perm_b32 v120, v41, v40, s30
    v_perm_b32 v121, v43, v42, s30
    v_perm_b32 v122, v45, v44, s30
    v_perm_b32 v123, v47, v46, s30
    v_perm_b32 v124, v41, v40, s31
    v_perm_b32 v125, v43, v42, s31
    v_perm_b32 v126, v45, v44, s31
    v_perm_b32 v127, v47, v46, s31
    v_add_u32 v13, v18, v8
    v_add_u32 v14, v19, v8
    v_cndmask_b32 v140, v124, v120, s[46:47]
    v_cndmask_b32 v141, v125, v121, s[46:47]
    v_cndmask_b32 v142, v126, v122, s[46:47]
    v_cndmask_b32 v143, v127, v123, s[46:47]
    v_mov_b32_dpp v140, v140 row_half_mirror row_mask:0xf bank_mask:0xf
    v_mov_b32_dpp v141, v141 row_half_mirror row_mask:0xf bank_mask:0xf
    v_mov_b32_dpp v142, v142 row_half_mirror row_mask:0xf bank_mask:0xf
    v_mov_b32_dpp v143, v143 row_half_mirror row_mask:0xf bank_mask:0xf
    v_cndmask_b32 v144, v120, v140, s[46:47]
    v_cndmask_b32 v145, v121, v141, s[46:47]
    v_cndmask_b32 v146, v122, v142, s[46:47]
    v_cndmask_b32 v147, v123, v143, s[46:47]
    global_store_dwordx4 v13, v[144:147], s[12:13] offset:0 sc1
    v_cndmask_b32 v148, v140, v124, s[46:47]
    v_cndmask_b32 v149, v141, v125, s[46:47]
    v_cndmask_b32 v150, v142, v126, s[46:47]
    v_cndmask_b32 v151, v143, v127, s[46:47]
    global_store_dwordx4 v14, v[148:151], s[12:13] offset:0 sc1
    s_waitcnt vmcnt(20)
    v_add_u32 v11, 16, v10
    v_mul_u32_u24 v12, 52, v11
    v_lshrrev_b32 v12, 8, v12
    v_lshl_add_u32 v8, v11, 10, v9
    v_mad_u32_u24 v8, v12, s20, v8
    v_perm_b32 v112, v49, v48, s30
    v_perm_b32 v113, v51, v50, s30
    v_perm_b32 v114, v53, v52, s30
    v_perm_b32 v115, v55, v54, s30
    v_perm_b32 v116, v49, v48, s31
    v_perm_b32 v117, v51, v50, s31
    v_perm_b32 v118, v53, v52, s31
    v_perm_b32 v119, v55, v54, s31
    v_add_u32 v13, v18, v8
    v_add_u32 v14, v19, v8
    v_cndmask_b32 v128, v116, v112, s[46:47]
    v_cndmask_b32 v129, v117, v113, s[46:47]
    v_cndmask_b32 v130, v118, v114, s[46:47]
    v_cndmask_b32 v131, v119, v115, s[46:47]
    v_mov_b32_dpp v128, v128 row_half_mirror row_mask:0xf bank_mask:0xf
    v_mov_b32_dpp v129, v129 row_half_mirror row_mask:0xf bank_mask:0xf
    v_mov_b32_dpp v130, v130 row_half_mirror row_mask:0xf bank_mask:0xf
    v_mov_b32_dpp v131, v131 row_half_mirror row_mask:0xf bank_mask:0xf
    v_cndmask_b32 v132, v112, v128, s[46:47]
    v_cndmask_b32 v133, v113, v129, s[46:47]
    v_cndmask_b32 v134, v114, v130, s[46:47]
    v_cndmask_b32 v135, v115, v131, s[46:47]
    global_store_dwordx4 v13, v[132:135], s[12:13] offset:0 sc1
    v_cndmask_b32 v136, v128, v116, s[46:47]
    v_cndmask_b32 v137, v129, v117, s[46:47]
    v_cndmask_b32 v138, v130, v118, s[46:47]
    v_cndmask_b32 v139, v131, v119, s[46:47]
    global_store_dwordx4 v14, v[136:139], s[12:13] offset:0 sc1
    s_waitcnt vmcnt(14)
    v_add_u32 v11, 24, v10
    v_mul_u32_u24 v12, 52, v11
    v_lshrrev_b32 v12, 8, v12
    v_lshl_add_u32 v8, v11, 10, v9
    v_mad_u32_u24 v8, v12, s20, v8
    v_perm_b32 v120, v57, v56, s30
    v_perm_b32 v121, v59, v58, s30
    v_perm_b32 v122, v61, v60, s30
    v_perm_b32 v123, v63, v62, s30
    v_perm_b32 v124, v57, v56, s31
    v_perm_b32 v125, v59, v58, s31
    v_perm_b32 v126, v61, v60, s31
    v_perm_b32 v127, v63, v62, s31
    v_add_u32 v13, v18, v8
    v_add_u32 v14, v19, v8
    v_cndmask_b32 v140, v124, v120, s[46:47]
    v_cndmask_b32 v141, v125, v121, s[46:47]
    v_cndmask_b32 v142, v126, v122, s[46:47]
    v_cndmask_b32 v143, v127, v123, s[46:47]
    v_mov_b32_dpp v140, v140 row_half_mirror row_mask:0xf bank_mask:0xf
    v_mov_b32_dpp v141, v141 row_half_mirror row_mask:0xf bank_mask:0xf
    v_mov_b32_dpp v142, v142 row_half_mirror row_mask:0xf bank_mask:0xf
    v_mov_b32_dpp v143, v143 row_half_mirror row_mask:0xf bank_mask:0xf
    v_cndmask_b32 v144, v120, v140, s[46:47]
    v_cndmask_b32 v145, v121, v141, s[46:47]
    v_cndmask_b32 v146, v122, v142, s[46:47]
    v_cndmask_b32 v147, v123, v143, s[46:47]
    global_store_dwordx4 v13, v[144:147], s[12:13] offset:0 sc1
    v_cndmask_b32 v148, v140, v124, s[46:47]
    v_cndmask_b32 v149, v141, v125, s[46:47]
    v_cndmask_b32 v150, v142, v126, s[46:47]
    v_cndmask_b32 v151, v143, v127, s[46:47]
    global_store_dwordx4 v14, v[148:151], s[12:13] offset:0 sc1
    s_waitcnt vmcnt(8)
    v_add_u32 v11, 32, v10
    v_mul_u32_u24 v12, 52, v11
    v_lshrrev_b32 v12, 8, v12
    v_lshl_add_u32 v8, v11, 10, v9
    v_mad_u32_u24 v8, v12, s20, v8
    v_perm_b32 v112, v65, v64, s30
    v_perm_b32 v113, v67, v66, s30
    v_perm_b32 v114, v69, v68, s30
    v_perm_b32 v115, v71, v70, s30
    v_perm_b32 v116, v65, v64, s31
    v_perm_b32 v117, v67, v66, s31
    v_perm_b32 v118, v69, v68, s31
    v_perm_b32 v119, v71, v70, s31
    v_add_u32 v13, v18, v8
    v_add_u32 v14, v19, v8
    v_cndmask_b32 v128, v116, v112, s[46:47]
    v_cndmask_b32 v129, v117, v113, s[46:47]
    v_cndmask_b32 v130, v118, v114, s[46:47]
    v_cndmask_b32 v131, v119, v115, s[46:47]
    v_mov_b32_dpp v128, v128 row_half_mirror row_mask:0xf bank_mask:0xf
    v_mov_b32_dpp v129, v129 row_half_mirror row_mask:0xf bank_mask:0xf
    v_mov_b32_dpp v130, v130 row_half_mirror row_mask:0xf bank_mask:0xf
    v_mov_b32_dpp v131, v131 row_half_mirror row_mask:0xf bank_mask:0xf
    v_cndmask_b32 v132, v112, v128, s[46:47]
    v_cndmask_b32 v133, v113, v129, s[46:47]
    v_cndmask_b32 v134, v114, v130, s[46:47]
    v_cndmask_b32 v135, v115, v131, s[46:47]
    global_store_dwordx4 v13, v[132:135], s[12:13] offset:0 sc1
    v_cndmask_b32 v136, v128, v116, s[46:47]
    v_cndmask_b32 v137, v129, v117, s[46:47]
    v_cndmask_b32 v138, v130, v118, s[46:47]
    v_cndmask_b32 v139, v131, v119, s[46:47]
    global_store_dwordx4 v14, v[136:139], s[12:13] offset:0 sc1
    v_mov_b32 v16, 0
    s_cmp_ge_u32 s3, 32
    s_cbranch_scc1 K1_P2CNT
    v_mov_b32 v17, 0
    v_mov_b32 v18, 0
    v_mov_b32 v19, 0
    s_cmp_ge_u32 s3, 28
    s_cbranch_scc1 K1_P2END
    s_lshl_b32 s20, s3, 12
    s_add_u32 s20, s20, 7979008
    v_and_b32 v8, 255, v0
    v_lshlrev_b32 v8, 4, v8
    v_add_u32 v8, s20, v8
    global_store_dwordx4 v8, v[16:19], s[12:13] sc1
    s_branch K1_P2END
K1_P2CNT:
    s_cmp_lg_u32 s14, 0
    s_cbranch_scc1 K1_P2END
    s_lshl_b32 s20, s3, 10
    s_add_u32 s20, s20, 20455424
    v_lshlrev_b32 v8, 7, v2
    v_add_u32 v8, s20, v8
    s_mov_b64 exec, 31
    global_store_dword v8, v16, s[12:13] sc1
    s_mov_b64 exec, -1
K1_P2END:
    s_branch K34_JOIN
K1_END:
    s_endpgm
K34_CODE:
K34_JOIN:
    s_mov_b64 exec, -1
    s_setprio 0
    s_load_dwordx2 s[10:11], s[0:1], 96
    s_load_dwordx2 s[48:49], s[0:1], 80
    v_lshrrev_b32 v1, 6, v0
    v_and_b32 v2, 63, v0
    v_readfirstlane_b32 s14, v1
    s_and_b32 s3, s2, 1
    s_lshl_b32 s3, s3, 3
    s_bfe_u32 s15, s2, 0x30003
    s_add_u32 s3, s3, s15
    s_bfe_u32 s15, s2, 0x20001
    s_lshl_b32 s15, s15, 2
    s_lshr_b32 s16, s2, 6
    s_add_u32 s15, s15, s16
    v_lshlrev_b32 v3, 4, v2
    s_lshl_b32 s17, s3, 10
    s_add_u32 s17, s17, 5341184
    s_mul_i32 s18, s15, 258048
    s_add_u32 s18, s18, 8093696
    s_mov_b32 s6, 20512768
    s_mov_b32 s7, 0x20000
    s_mov_b32 s36, -1
    s_mov_b32 s37, 0
    s_mov_b32 s40, s14
    s_bfe_u32 s41, s2, 0x10001
    s_lshl_b32 s42, s3, 1
    s_add_u32 s41, s41, s42
    s_bfe_u32 s42, s2, 0x10002
    s_lshl_b32 s42, s42, 2
    s_add_u32 s42, s42, s16
    s_mul_i32 s43, s42, 245760
    s_mul_i32 s44, s14, 30720
    s_add_u32 s43, s43, s44
    s_add_u32 s43, s43, 12222464
    s_waitcnt lgkmcnt(0)
    s_mov_b32 s4, s10
    s_mov_b32 s5, s11
    s_mov_b32 s12, s10
    s_mov_b32 s13, s11
    s_cmp_ge_u32 s14, 4
    s_cbranch_scc1 K3_LOADER
    s_and_b32 s24, s14, 1
    s_lshl_b32 s24, s24, 9
    v_and_b32 v14, 15, v2
    v_lshlrev_b32 v14, 3, v14
    v_lshrrev_b32 v15, 4, v2
    v_lshl_add_u32 v14, v15, 10, v14
    v_and_b32 v15, 1, v15
    v_lshl_add_u32 v14, v15, 7, v14
    v_add_u32 v14, s24, v14
    v_add_u32 v15, 61440, v14
    v_add_u32 v16, 122880, v14
    v_xor_b32 v1, 128, v14
    v_xor_b32 v12, 128, v15
    v_xor_b32 v13, 128, v16
    s_lshr_b32 s25, s14, 1
    s_mul_i32 s24, s25, 6144
    s_add_u32 s24, s24, 8192
    v_add_u32 v17, s24, v3
    v_add_u32 v18, 61440, v17
    v_add_u32 v19, 122880, v17
    s_lshl_b32 s24, s3, 1
    s_and_b32 s26, s14, 1
    s_add_u32 s24, s24, s26
    s_mul_i32 s24, s24, 196608
    s_mul_i32 s26, s15, 12288
    s_add_u32 s24, s24, s26
    s_add_u32 s24, s24, 14188544
    s_lshl_b32 s26, s25, 13
    s_add_u32 s26, s26, s24
    v_add_u32 v20, s26, v3
    s_lshl_b32 s26, s25, 9
    s_add_u32 s26, s26, s24
    s_add_u32 s26, s26, 4096
    v_add_u32 v21, s26, v3
    v_and_b32 v22, 1, v2
    v_lshrrev_b32 v21, 1, v2
    v_lshlrev_b32 v21, 4, v21
    v_lshl_add_u32 v21, v22, 10, v21
    v_add_u32 v21, s26, v21
    v_cmp_eq_u32 s[38:39], 1, v22
    s_lshl_b32 s26, s3, 10
    s_add_u32 s26, s26, 20488320
    s_lshl_b32 s27, s14, 7
    s_add_u32 s27, s27, s26
    v_cmp_eq_u32 vcc, 0, v2
    v_mov_b32 v23, 0x7ffffff0
    v_mov_b32 v24, s27
    v_cndmask_b32 v23, v23, v24, vcc
    v_mov_b32 v24, 1
    s_lshr_b32 s26, s41, 1
    s_lshl_b32 s26, s26, 10
    s_add_u32 s26, s26, 20488320
    s_and_b32 s27, s41, 1
    s_lshl_b32 s27, s27, 7
    s_add_u32 s27, s27, s26
    v_lshlrev_b32 v25, 8, v22
    v_add_u32 v25, s27, v25
    s_bfe_u32 s26, s2, 0x10002
    s_mul_i32 s26, s26, 983040
    s_lshr_b32 s27, s2, 3
    s_mul_i32 s27, s27, 30720
    s_add_u32 s26, s26, s27
    s_mul_i32 s27, s14, 7680
    s_add_u32 s26, s26, s27
    s_add_u32 s26, s26, 12222464
    v_min_u32 v26, 59, v2
    v_lshlrev_b32 v26, 7, v26
    v_add_u32 v26, s26, v26
    s_waitcnt vmcnt(0)
    s_barrier
    s_barrier
    s_barrier
    ds_read_b128 v[168:171], v17 offset:0
    ds_read_b64 v[152:153], v14 offset:0
    ds_read_b64 v[154:155], v14 offset:4096
    ds_read_b128 v[172:175], v17 offset:1024
    ds_read_b128 v[176:179], v17 offset:2048
    ds_read_b128 v[180:183], v17 offset:3072
    ds_read_b128 v[184:187], v17 offset:4096
    ds_read_b128 v[188:191], v17 offset:5120
    ds_read_b64 v[156:157], v1 offset:0
    ds_read_b64 v[158:159], v1 offset:4096
    ds_read_b64 v[160:161], v14 offset:256
    ds_read_b64 v[162:163], v14 offset:4352
    ds_read_b64 v[164:165], v1 offset:256
    ds_read_b64 v[166:167], v1 offset:4352
    s_waitcnt lgkmcnt(11)
    v_mfma_f32_16x16x32_bf16 v[32:35], v[168:171], v[152:155], 0
    s_waitcnt lgkmcnt(10)
    v_mfma_f32_16x16x32_bf16 v[36:39], v[172:175], v[152:155], 0
    s_barrier
    ds_read_b128 v[208:211], v17 offset:20480
    s_waitcnt lgkmcnt(10)
    v_mfma_f32_16x16x32_bf16 v[40:43], v[176:179], v[152:155], 0
    s_waitcnt lgkmcnt(9)
    v_mfma_f32_16x16x32_bf16 v[44:47], v[180:183], v[152:155], 0
    ds_read_b64 v[192:193], v14 offset:20480
    ds_read_b64 v[194:195], v14 offset:24576
    s_waitcnt lgkmcnt(10)
    v_mfma_f32_16x16x32_bf16 v[48:51], v[184:187], v[152:155], 0
    s_waitcnt lgkmcnt(9)
    v_mfma_f32_16x16x32_bf16 v[52:55], v[188:191], v[152:155], 0
    ds_read_b128 v[212:215], v17 offset:21504
    s_waitcnt lgkmcnt(8)
    v_mfma_f32_16x16x32_bf16 v[56:59], v[168:171], v[156:159], 0
    v_mfma_f32_16x16x32_bf16 v[60:63], v[172:175], v[156:159], 0
    ds_read_b128 v[216:219], v17 offset:22528
    v_mfma_f32_16x16x32_bf16 v[64:67], v[176:179], v[156:159], 0
    v_mfma_f32_16x16x32_bf16 v[68:71], v[180:183], v[156:159], 0
    ds_read_b128 v[220:223], v17 offset:23552
    v_mfma_f32_16x16x32_bf16 v[72:75], v[184:187], v[156:159], 0
    v_mfma_f32_16x16x32_bf16 v[76:79], v[188:191], v[156:159], 0
    ds_read_b128 v[224:227], v17 offset:24576
    s_waitcnt lgkmcnt(9)
    v_mfma_f32_16x16x32_bf16 v[80:83], v[168:171], v[160:163], 0
    v_mfma_f32_16x16x32_bf16 v[84:87], v[172:175], v[160:163], 0
    ds_read_b128 v[228:231], v17 offset:25600
    v_mfma_f32_16x16x32_bf16 v[88:91], v[176:179], v[160:163], 0
    v_mfma_f32_16x16x32_bf16 v[92:95], v[180:183], v[160:163], 0
    ds_read_b64 v[196:197], v1 offset:20480
    ds_read_b64 v[198:199], v1 offset:24576
    v_mfma_f32_16x16x32_bf16 v[96:99], v[184:187], v[160:163], 0
    v_mfma_f32_16x16x32_bf16 v[100:103], v[188:191], v[160:163], 0
    ds_read_b64 v[200:201], v14 offset:20736
    ds_read_b64 v[202:203], v14 offset:24832
    s_waitcnt lgkmcnt(12)
    v_mfma_f32_16x16x32_bf16 v[104:107], v[168:171], v[164:167], 0
    v_mfma_f32_16x16x32_bf16 v[108:111], v[172:175], v[164:167], 0
    ds_read_b64 v[204:205], v1 offset:20736
    ds_read_b64 v[206:207], v1 offset:24832
    v_mfma_f32_16x16x32_bf16 v[112:115], v[176:179], v[164:167], 0
    v_mfma_f32_16x16x32_bf16 v[116:119], v[180:183], v[164:167], 0
    v_mfma_f32_16x16x32_bf16 v[120:123], v[184:187], v[164:167], 0
    v_mfma_f32_16x16x32_bf16 v[124:127], v[188:191], v[164:167], 0
    s_waitcnt lgkmcnt(11)
    v_mfma_f32_16x16x32_bf16 v[32:35], v[208:211], v[192:195], v[32:35]
    s_waitcnt lgkmcnt(10)
    v_mfma_f32_16x16x32_bf16 v[36:39], v[212:215], v[192:195], v[36:39]
    s_barrier
    ds_read_b128 v[168:171], v17 offset:40960
    s_waitcnt lgkmcnt(10)
    v_mfma_f32_16x16x32_bf16 v[40:43], v[216:219], v[192:195], v[40:43]
    s_waitcnt lgkmcnt(9)
    v_mfma_f32_16x16x32_bf16 v[44:47], v[220:223], v[192:195], v[44:47]
    ds_read_b64 v[152:153], v14 offset:40960
    ds_read_b64 v[154:155], v14 offset:45056
    s_waitcnt lgkmcnt(10)
    v_mfma_f32_16x16x32_bf16 v[48:51], v[224:227], v[192:195], v[48:51]
    s_waitcnt lgkmcnt(9)
    v_mfma_f32_16x16x32_bf16 v[52:55], v[228:231], v[192:195], v[52:55]
    ds_read_b128 v[172:175], v17 offset:41984
    s_waitcnt lgkmcnt(8)
    v_mfma_f32_16x16x32_bf16 v[56:59], v[208:211], v[196:199], v[56:59]
    v_mfma_f32_16x16x32_bf16 v[60:63], v[212:215], v[196:199], v[60:63]
    ds_read_b128 v[176:179], v17 offset:43008
    v_mfma_f32_16x16x32_bf16 v[64:67], v[216:219], v[196:199], v[64:67]
    v_mfma_f32_16x16x32_bf16 v[68:71], v[220:223], v[196:199], v[68:71]
    ds_read_b128 v[180:183], v17 offset:44032
    v_mfma_f32_16x16x32_bf16 v[72:75], v[224:227], v[196:199], v[72:75]
    v_mfma_f32_16x16x32_bf16 v[76:79], v[228:231], v[196:199], v[76:79]
    ds_read_b128 v[184:187], v17 offset:45056
    s_waitcnt lgkmcnt(9)
    v_mfma_f32_16x16x32_bf16 v[80:83], v[208:211], v[200:203], v[80:83]
    v_mfma_f32_16x16x32_bf16 v[84:87], v[212:215], v[200:203], v[84:87]
    ds_read_b128 v[188:191], v17 offset:46080
    v_mfma_f32_16x16x32_bf16 v[88:91], v[216:219], v[200:203], v[88:91]
    v_mfma_f32_16x16x32_bf16 v[92:95], v[220:223], v[200:203], v[92:95]
    ds_read_b64 v[156:157], v1 offset:40960
    ds_read_b64 v[158:159], v1 offset:45056
    v_mfma_f32_16x16x32_bf16 v[96:99], v[224:227], v[200:203], v[96:99]
    v_mfma_f32_16x16x32_bf16 v[100:103], v[228:231], v[200:203], v[100:103]
    ds_read_b64 v[160:161], v14 offset:41216
    ds_read_b64 v[162:163], v14 offset:45312
    s_waitcnt lgkmcnt(12)
    v_mfma_f32_16x16x32_bf16 v[104:107], v[208:211], v[204:207], v[104:107]
    v_mfma_f32_16x16x32_bf16 v[108:111], v[212:215], v[204:207], v[108:111]
    ds_read_b64 v[164:165], v1 offset:41216
    ds_read_b64 v[166:167], v1 offset:45312
    v_mfma_f32_16x16x32_bf16 v[112:115], v[216:219], v[204:207], v[112:115]
    v_mfma_f32_16x16x32_bf16 v[116:119], v[220:223], v[204:207], v[116:119]
    v_mfma_f32_16x16x32_bf16 v[120:123], v[224:227], v[204:207], v[120:123]
    v_mfma_f32_16x16x32_bf16 v[124:127], v[228:231], v[204:207], v[124:127]
    s_waitcnt lgkmcnt(11)
    v_mfma_f32_16x16x32_bf16 v[32:35], v[168:171], v[152:155], v[32:35]
    s_waitcnt lgkmcnt(10)
    v_mfma_f32_16x16x32_bf16 v[36:39], v[172:175], v[152:155], v[36:39]
    s_barrier
    ds_read_b128 v[208:211], v18 offset:0
    s_waitcnt lgkmcnt(10)
    v_mfma_f32_16x16x32_bf16 v[40:43], v[176:179], v[152:155], v[40:43]
    s_waitcnt lgkmcnt(9)
    v_mfma_f32_16x16x32_bf16 v[44:47], v[180:183], v[152:155], v[44:47]
    ds_read_b64 v[192:193], v15 offset:0
    ds_read_b64 v[194:195], v15 offset:4096
    s_waitcnt lgkmcnt(10)
    v_mfma_f32_16x16x32_bf16 v[48:51], v[184:187], v[152:155], v[48:51]
    s_waitcnt lgkmcnt(9)
    v_mfma_f32_16x16x32_bf16 v[52:55], v[188:191], v[152:155], v[52:55]
    ds_read_b128 v[212:215], v18 offset:1024
    s_waitcnt lgkmcnt(8)
    v_mfma_f32_16x16x32_bf16 v[56:59], v[168:171], v[156:159], v[56:59]
    v_mfma_f32_16x16x32_bf16 v[60:63], v[172:175], v[156:159], v[60:63]
    ds_read_b128 v[216:219], v18 offset:2048
    v_mfma_f32_16x16x32_bf16 v[64:67], v[176:179], v[156:159], v[64:67]
    v_mfma_f32_16x16x32_bf16 v[68:71], v[180:183], v[156:159], v[68:71]
    ds_read_b128 v[220:223], v18 offset:3072
    v_mfma_f32_16x16x32_bf16 v[72:75], v[184:187], v[156:159], v[72:75]
    v_mfma_f32_16x16x32_bf16 v[76:79], v[188:191], v[156:159], v[76:79]
    ds_read_b128 v[224:227], v18 offset:4096
    s_waitcnt lgkmcnt(9)
    v_mfma_f32_16x16x32_bf16 v[80:83], v[168:171], v[160:163], v[80:83]
    v_mfma_f32_16x16x32_bf16 v[84:87], v[172:175], v[160:163], v[84:87]
    ds_read_b128 v[228:231], v18 offset:5120
    v_mfma_f32_16x16x32_bf16 v[88:91], v[176:179], v[160:163], v[88:91]
    v_mfma_f32_16x16x32_bf16 v[92:95], v[180:183], v[160:163], v[92:95]
    ds_read_b64 v[196:197], v12 offset:0
    ds_read_b64 v[198:199], v12 offset:4096
    v_mfma_f32_16x16x32_bf16 v[96:99], v[184:187], v[160:163], v[96:99]
    v_mfma_f32_16x16x32_bf16 v[100:103], v[188:191], v[160:163], v[100:103]
    ds_read_b64 v[200:201], v15 offset:256
    ds_read_b64 v[202:203], v15 offset:4352
    s_waitcnt lgkmcnt(12)
    v_mfma_f32_16x16x32_bf16 v[104:107], v[168:171], v[164:167], v[104:107]
    v_mfma_f32_16x16x32_bf16 v[108:111], v[172:175], v[164:167], v[108:111]
    ds_read_b64 v[204:205], v12 offset:256
    ds_read_b64 v[206:207], v12 offset:4352
    v_mfma_f32_16x16x32_bf16 v[112:115], v[176:179], v[164:167], v[112:115]
    v_mfma_f32_16x16x32_bf16 v[116:119], v[180:183], v[164:167], v[116:119]
    v_mfma_f32_16x16x32_bf16 v[120:123], v[184:187], v[164:167], v[120:123]
    v_mfma_f32_16x16x32_bf16 v[124:127], v[188:191], v[164:167], v[124:127]
    s_waitcnt lgkmcnt(11)
    v_mfma_f32_16x16x32_bf16 v[32:35], v[208:211], v[192:195], v[32:35]
    s_waitcnt lgkmcnt(10)
    v_mfma_f32_16x16x32_bf16 v[36:39], v[212:215], v[192:195], v[36:39]
    s_barrier
    ds_read_b128 v[168:171], v18 offset:20480
    s_waitcnt lgkmcnt(10)
    v_mfma_f32_16x16x32_bf16 v[40:43], v[216:219], v[192:195], v[40:43]
    s_waitcnt lgkmcnt(9)
    v_mfma_f32_16x16x32_bf16 v[44:47], v[220:223], v[192:195], v[44:47]
    ds_read_b64 v[152:153], v15 offset:20480
    ds_read_b64 v[154:155], v15 offset:24576
    s_waitcnt lgkmcnt(10)
    v_mfma_f32_16x16x32_bf16 v[48:51], v[224:227], v[192:195], v[48:51]
    s_waitcnt lgkmcnt(9)
    v_mfma_f32_16x16x32_bf16 v[52:55], v[228:231], v[192:195], v[52:55]
    ds_read_b128 v[172:175], v18 offset:21504
    s_waitcnt lgkmcnt(8)
    v_mfma_f32_16x16x32_bf16 v[56:59], v[208:211], v[196:199], v[56:59]
    v_mfma_f32_16x16x32_bf16 v[60:63], v[212:215], v[196:199], v[60:63]
    ds_read_b128 v[176:179], v18 offset:22528
    v_mfma_f32_16x16x32_bf16 v[64:67], v[216:219], v[196:199], v[64:67]
    v_mfma_f32_16x16x32_bf16 v[68:71], v[220:223], v[196:199], v[68:71]
    ds_read_b128 v[180:183], v18 offset:23552
    v_mfma_f32_16x16x32_bf16 v[72:75], v[224:227], v[196:199], v[72:75]
    v_mfma_f32_16x16x32_bf16 v[76:79], v[228:231], v[196:199], v[76:79]
    ds_read_b128 v[184:187], v18 offset:24576
    s_waitcnt lgkmcnt(9)
    v_mfma_f32_16x16x32_bf16 v[80:83], v[208:211], v[200:203], v[80:83]
    v_mfma_f32_16x16x32_bf16 v[84:87], v[212:215], v[200:203], v[84:87]
    ds_read_b128 v[188:191], v18 offset:25600
    v_mfma_f32_16x16x32_bf16 v[88:91], v[216:219], v[200:203], v[88:91]
    v_mfma_f32_16x16x32_bf16 v[92:95], v[220:223], v[200:203], v[92:95]
    ds_read_b64 v[156:157], v12 offset:20480
    ds_read_b64 v[158:159], v12 offset:24576
    v_mfma_f32_16x16x32_bf16 v[96:99], v[224:227], v[200:203], v[96:99]
    v_mfma_f32_16x16x32_bf16 v[100:103], v[228:231], v[200:203], v[100:103]
    ds_read_b64 v[160:161], v15 offset:20736
    ds_read_b64 v[162:163], v15 offset:24832
    s_waitcnt lgkmcnt(12)
    v_mfma_f32_16x16x32_bf16 v[104:107], v[208:211], v[204:207], v[104:107]
    v_mfma_f32_16x16x32_bf16 v[108:111], v[212:215], v[204:207], v[108:111]
    ds_read_b64 v[164:165], v12 offset:20736
    ds_read_b64 v[166:167], v12 offset:24832
    v_mfma_f32_16x16x32_bf16 v[112:115], v[216:219], v[204:207], v[112:115]
    v_mfma_f32_16x16x32_bf16 v[116:119], v[220:223], v[204:207], v[116:119]
    v_mfma_f32_16x16x32_bf16 v[120:123], v[224:227], v[204:207], v[120:123]
    v_mfma_f32_16x16x32_bf16 v[124:127], v[228:231], v[204:207], v[124:127]
    s_waitcnt lgkmcnt(11)
    v_mfma_f32_16x16x32_bf16 v[32:35], v[168:171], v[152:155], v[32:35]
    s_waitcnt lgkmcnt(10)
    v_mfma_f32_16x16x32_bf16 v[36:39], v[172:175], v[152:155], v[36:39]
    s_barrier
    ds_read_b128 v[208:211], v17 offset:0
    s_waitcnt lgkmcnt(10)
    v_mfma_f32_16x16x32_bf16 v[40:43], v[176:179], v[152:155], v[40:43]
    s_waitcnt lgkmcnt(9)
    v_mfma_f32_16x16x32_bf16 v[44:47], v[180:183], v[152:155], v[44:47]
    ds_read_b64 v[192:193], v14 offset:0
    ds_read_b64 v[194:195], v14 offset:4096
    s_waitcnt lgkmcnt(10)
    v_mfma_f32_16x16x32_bf16 v[48:51], v[184:187], v[152:155], v[48:51]
    s_waitcnt lgkmcnt(9)
    v_mfma_f32_16x16x32_bf16 v[52:55], v[188:191], v[152:155], v[52:55]
    ds_read_b128 v[212:215], v17 offset:1024
    s_waitcnt lgkmcnt(8)
    v_mfma_f32_16x16x32_bf16 v[56:59], v[168:171], v[156:159], v[56:59]
    v_mfma_f32_16x16x32_bf16 v[60:63], v[172:175], v[156:159], v[60:63]
    ds_read_b128 v[216:219], v17 offset:2048
    v_mfma_f32_16x16x32_bf16 v[64:67], v[176:179], v[156:159], v[64:67]
    v_mfma_f32_16x16x32_bf16 v[68:71], v[180:183], v[156:159], v[68:71]
    ds_read_b128 v[220:223], v17 offset:3072
    v_mfma_f32_16x16x32_bf16 v[72:75], v[184:187], v[156:159], v[72:75]
    v_mfma_f32_16x16x32_bf16 v[76:79], v[188:191], v[156:159], v[76:79]
    ds_read_b128 v[224:227], v17 offset:4096
    s_waitcnt lgkmcnt(9)
    v_mfma_f32_16x16x32_bf16 v[80:83], v[168:171], v[160:163], v[80:83]
    v_mfma_f32_16x16x32_bf16 v[84:87], v[172:175], v[160:163], v[84:87]
    ds_read_b128 v[228:231], v17 offset:5120
    v_mfma_f32_16x16x32_bf16 v[88:91], v[176:179], v[160:163], v[88:91]
    v_mfma_f32_16x16x32_bf16 v[92:95], v[180:183], v[160:163], v[92:95]
    ds_read_b64 v[196:197], v1 offset:0
    ds_read_b64 v[198:199], v1 offset:4096
    v_mfma_f32_16x16x32_bf16 v[96:99], v[184:187], v[160:163], v[96:99]
    v_mfma_f32_16x16x32_bf16 v[100:103], v[188:191], v[160:163], v[100:103]
    ds_read_b64 v[200:201], v14 offset:256
    ds_read_b64 v[202:203], v14 offset:4352
    s_waitcnt lgkmcnt(12)
    v_mfma_f32_16x16x32_bf16 v[104:107], v[168:171], v[164:167], v[104:107]
    v_mfma_f32_16x16x32_bf16 v[108:111], v[172:175], v[164:167], v[108:111]
    ds_read_b64 v[204:205], v1 offset:256
    ds_read_b64 v[206:207], v1 offset:4352
    v_mfma_f32_16x16x32_bf16 v[112:115], v[176:179], v[164:167], v[112:115]
    v_mfma_f32_16x16x32_bf16 v[116:119], v[180:183], v[164:167], v[116:119]
    v_mfma_f32_16x16x32_bf16 v[120:123], v[184:187], v[164:167], v[120:123]
    v_mfma_f32_16x16x32_bf16 v[124:127], v[188:191], v[164:167], v[124:127]
    s_waitcnt lgkmcnt(11)
    v_mfma_f32_16x16x32_bf16 v[32:35], v[208:211], v[192:195], v[32:35]
    s_waitcnt lgkmcnt(10)
    v_mfma_f32_16x16x32_bf16 v[36:39], v[212:215], v[192:195], v[36:39]
    s_barrier
    ds_read_b128 v[168:171], v17 offset:20480
    s_waitcnt lgkmcnt(10)
    v_mfma_f32_16x16x32_bf16 v[40:43], v[216:219], v[192:195], v[40:43]
    s_waitcnt lgkmcnt(9)
    v_mfma_f32_16x16x32_bf16 v[44:47], v[220:223], v[192:195], v[44:47]
    ds_read_b64 v[152:153], v14 offset:20480
    ds_read_b64 v[154:155], v14 offset:24576
    s_waitcnt lgkmcnt(10)
    v_mfma_f32_16x16x32_bf16 v[48:51], v[224:227], v[192:195], v[48:51]
    s_waitcnt lgkmcnt(9)
    v_mfma_f32_16x16x32_bf16 v[52:55], v[228:231], v[192:195], v[52:55]
    ds_read_b128 v[172:175], v17 offset:21504
    s_waitcnt lgkmcnt(8)
    v_mfma_f32_16x16x32_bf16 v[56:59], v[208:211], v[196:199], v[56:59]
    v_mfma_f32_16x16x32_bf16 v[60:63], v[212:215], v[196:199], v[60:63]
    ds_read_b128 v[176:179], v17 offset:22528
    v_mfma_f32_16x16x32_bf16 v[64:67], v[216:219], v[196:199], v[64:67]
    v_mfma_f32_16x16x32_bf16 v[68:71], v[220:223], v[196:199], v[68:71]
    ds_read_b128 v[180:183], v17 offset:23552
    v_mfma_f32_16x16x32_bf16 v[72:75], v[224:227], v[196:199], v[72:75]
    v_mfma_f32_16x16x32_bf16 v[76:79], v[228:231], v[196:199], v[76:79]
    ds_read_b128 v[184:187], v17 offset:24576
    s_waitcnt lgkmcnt(9)
    v_mfma_f32_16x16x32_bf16 v[80:83], v[208:211], v[200:203], v[80:83]
    v_mfma_f32_16x16x32_bf16 v[84:87], v[212:215], v[200:203], v[84:87]
    ds_read_b128 v[188:191], v17 offset:25600
    v_mfma_f32_16x16x32_bf16 v[88:91], v[216:219], v[200:203], v[88:91]
    v_mfma_f32_16x16x32_bf16 v[92:95], v[220:223], v[200:203], v[92:95]
    ds_read_b64 v[156:157], v1 offset:20480
    ds_read_b64 v[158:159], v1 offset:24576
    v_mfma_f32_16x16x32_bf16 v[96:99], v[224:227], v[200:203], v[96:99]
    v_mfma_f32_16x16x32_bf16 v[100:103], v[228:231], v[200:203], v[100:103]
    ds_read_b64 v[160:161], v14 offset:20736
    ds_read_b64 v[162:163], v14 offset:24832
    s_waitcnt lgkmcnt(12)
    v_mfma_f32_16x16x32_bf16 v[104:107], v[208:211], v[204:207], v[104:107]
    v_mfma_f32_16x16x32_bf16 v[108:111], v[212:215], v[204:207], v[108:111]
    ds_read_b64 v[164:165], v1 offset:20736
    ds_read_b64 v[166:167], v1 offset:24832
    v_mfma_f32_16x16x32_bf16 v[112:115], v[216:219], v[204:207], v[112:115]
    v_mfma_f32_16x16x32_bf16 v[116:119], v[220:223], v[204:207], v[116:119]
    v_mfma_f32_16x16x32_bf16 v[120:123], v[224:227], v[204:207], v[120:123]
    v_mfma_f32_16x16x32_bf16 v[124:127], v[228:231], v[204:207], v[124:127]
    s_waitcnt lgkmcnt(11)
    v_mfma_f32_16x16x32_bf16 v[32:35], v[168:171], v[152:155], v[32:35]
    s_waitcnt lgkmcnt(10)
    v_mfma_f32_16x16x32_bf16 v[36:39], v[172:175], v[152:155], v[36:39]
    s_barrier
    ds_read_b128 v[208:211], v17 offset:40960
    s_waitcnt lgkmcnt(10)
    v_mfma_f32_16x16x32_bf16 v[40:43], v[176:179], v[152:155], v[40:43]
    s_waitcnt lgkmcnt(9)
    v_mfma_f32_16x16x32_bf16 v[44:47], v[180:183], v[152:155], v[44:47]
    ds_read_b64 v[192:193], v14 offset:40960
    ds_read_b64 v[194:195], v14 offset:45056
    s_waitcnt lgkmcnt(10)
    v_mfma_f32_16x16x32_bf16 v[48:51], v[184:187], v[152:155], v[48:51]
    s_waitcnt lgkmcnt(9)
    v_mfma_f32_16x16x32_bf16 v[52:55], v[188:191], v[152:155], v[52:55]
    ds_read_b128 v[212:215], v17 offset:41984
    s_waitcnt lgkmcnt(8)
    v_mfma_f32_16x16x32_bf16 v[56:59], v[168:171], v[156:159], v[56:59]
    v_mfma_f32_16x16x32_bf16 v[60:63], v[172:175], v[156:159], v[60:63]
    ds_read_b128 v[216:219], v17 offset:43008
    v_mfma_f32_16x16x32_bf16 v[64:67], v[176:179], v[156:159], v[64:67]
    v_mfma_f32_16x16x32_bf16 v[68:71], v[180:183], v[156:159], v[68:71]
    ds_read_b128 v[220:223], v17 offset:44032
    v_mfma_f32_16x16x32_bf16 v[72:75], v[184:187], v[156:159], v[72:75]
    v_mfma_f32_16x16x32_bf16 v[76:79], v[188:191], v[156:159], v[76:79]
    ds_read_b128 v[224:227], v17 offset:45056
    s_waitcnt lgkmcnt(9)
    v_mfma_f32_16x16x32_bf16 v[80:83], v[168:171], v[160:163], v[80:83]
    v_mfma_f32_16x16x32_bf16 v[84:87], v[172:175], v[160:163], v[84:87]
    ds_read_b128 v[228:231], v17 offset:46080
    v_mfma_f32_16x16x32_bf16 v[88:91], v[176:179], v[160:163], v[88:91]
    v_mfma_f32_16x16x32_bf16 v[92:95], v[180:183], v[160:163], v[92:95]
    ds_read_b64 v[196:197], v1 offset:40960
    ds_read_b64 v[198:199], v1 offset:45056
    v_mfma_f32_16x16x32_bf16 v[96:99], v[184:187], v[160:163], v[96:99]
    v_mfma_f32_16x16x32_bf16 v[100:103], v[188:191], v[160:163], v[100:103]
    ds_read_b64 v[200:201], v14 offset:41216
    ds_read_b64 v[202:203], v14 offset:45312
    s_waitcnt lgkmcnt(12)
    v_mfma_f32_16x16x32_bf16 v[104:107], v[168:171], v[164:167], v[104:107]
    v_mfma_f32_16x16x32_bf16 v[108:111], v[172:175], v[164:167], v[108:111]
    ds_read_b64 v[204:205], v1 offset:41216
    ds_read_b64 v[206:207], v1 offset:45312
    v_mfma_f32_16x16x32_bf16 v[112:115], v[176:179], v[164:167], v[112:115]
    v_mfma_f32_16x16x32_bf16 v[116:119], v[180:183], v[164:167], v[116:119]
    v_mfma_f32_16x16x32_bf16 v[120:123], v[184:187], v[164:167], v[120:123]
    v_mfma_f32_16x16x32_bf16 v[124:127], v[188:191], v[164:167], v[124:127]
    s_waitcnt lgkmcnt(11)
    v_mfma_f32_16x16x32_bf16 v[32:35], v[208:211], v[192:195], v[32:35]
    s_waitcnt lgkmcnt(10)
    v_mfma_f32_16x16x32_bf16 v[36:39], v[212:215], v[192:195], v[36:39]
    s_barrier
    ds_read_b128 v[168:171], v18 offset:0
    s_waitcnt lgkmcnt(10)
    v_mfma_f32_16x16x32_bf16 v[40:43], v[216:219], v[192:195], v[40:43]
    s_waitcnt lgkmcnt(9)
    v_mfma_f32_16x16x32_bf16 v[44:47], v[220:223], v[192:195], v[44:47]
    ds_read_b64 v[152:153], v15 offset:0
    ds_read_b64 v[154:155], v15 offset:4096
    s_waitcnt lgkmcnt(10)
    v_mfma_f32_16x16x32_bf16 v[48:51], v[224:227], v[192:195], v[48:51]
    s_waitcnt lgkmcnt(9)
    v_mfma_f32_16x16x32_bf16 v[52:55], v[228:231], v[192:195], v[52:55]
    ds_read_b128 v[172:175], v18 offset:1024
    s_waitcnt lgkmcnt(8)
    v_mfma_f32_16x16x32_bf16 v[56:59], v[208:211], v[196:199], v[56:59]
    v_mfma_f32_16x16x32_bf16 v[60:63], v[212:215], v[196:199], v[60:63]
    ds_read_b128 v[176:179], v18 offset:2048
    v_mfma_f32_16x16x32_bf16 v[64:67], v[216:219], v[196:199], v[64:67]
    v_mfma_f32_16x16x32_bf16 v[68:71], v[220:223], v[196:199], v[68:71]
    ds_read_b128 v[180:183], v18 offset:3072
    v_mfma_f32_16x16x32_bf16 v[72:75], v[224:227], v[196:199], v[72:75]
    v_mfma_f32_16x16x32_bf16 v[76:79], v[228:231], v[196:199], v[76:79]
    ds_read_b128 v[184:187], v18 offset:4096
    s_waitcnt lgkmcnt(9)
    v_mfma_f32_16x16x32_bf16 v[80:83], v[208:211], v[200:203], v[80:83]
    v_mfma_f32_16x16x32_bf16 v[84:87], v[212:215], v[200:203], v[84:87]
    ds_read_b128 v[188:191], v18 offset:5120
    v_mfma_f32_16x16x32_bf16 v[88:91], v[216:219], v[200:203], v[88:91]
    v_mfma_f32_16x16x32_bf16 v[92:95], v[220:223], v[200:203], v[92:95]
    ds_read_b64 v[156:157], v12 offset:0
    ds_read_b64 v[158:159], v12 offset:4096
    v_mfma_f32_16x16x32_bf16 v[96:99], v[224:227], v[200:203], v[96:99]
    v_mfma_f32_16x16x32_bf16 v[100:103], v[228:231], v[200:203], v[100:103]
    ds_read_b64 v[160:161], v15 offset:256
    ds_read_b64 v[162:163], v15 offset:4352
    s_waitcnt lgkmcnt(12)
    v_mfma_f32_16x16x32_bf16 v[104:107], v[208:211], v[204:207], v[104:107]
    v_mfma_f32_16x16x32_bf16 v[108:111], v[212:215], v[204:207], v[108:111]
    ds_read_b64 v[164:165], v12 offset:256
    ds_read_b64 v[166:167], v12 offset:4352
    v_mfma_f32_16x16x32_bf16 v[112:115], v[216:219], v[204:207], v[112:115]
    v_mfma_f32_16x16x32_bf16 v[116:119], v[220:223], v[204:207], v[116:119]
    v_mfma_f32_16x16x32_bf16 v[120:123], v[224:227], v[204:207], v[120:123]
    v_mfma_f32_16x16x32_bf16 v[124:127], v[228:231], v[204:207], v[124:127]
    s_waitcnt lgkmcnt(11)
    v_mfma_f32_16x16x32_bf16 v[32:35], v[168:171], v[152:155], v[32:35]
    s_waitcnt lgkmcnt(10)
    v_mfma_f32_16x16x32_bf16 v[36:39], v[172:175], v[152:155], v[36:39]
    s_barrier
    ds_read_b128 v[208:211], v18 offset:20480
    s_waitcnt lgkmcnt(10)
    v_mfma_f32_16x16x32_bf16 v[40:43], v[176:179], v[152:155], v[40:43]
    s_waitcnt lgkmcnt(9)
    v_mfma_f32_16x16x32_bf16 v[44:47], v[180:183], v[152:155], v[44:47]
    ds_read_b64 v[192:193], v15 offset:20480
    ds_read_b64 v[194:195], v15 offset:24576
    s_waitcnt lgkmcnt(10)
    v_mfma_f32_16x16x32_bf16 v[48:51], v[184:187], v[152:155], v[48:51]
    s_waitcnt lgkmcnt(9)
    v_mfma_f32_16x16x32_bf16 v[52:55], v[188:191], v[152:155], v[52:55]
    ds_read_b128 v[212:215], v18 offset:21504
    s_waitcnt lgkmcnt(8)
    v_mfma_f32_16x16x32_bf16 v[56:59], v[168:171], v[156:159], v[56:59]
    v_mfma_f32_16x16x32_bf16 v[60:63], v[172:175], v[156:159], v[60:63]
    ds_read_b128 v[216:219], v18 offset:22528
    v_mfma_f32_16x16x32_bf16 v[64:67], v[176:179], v[156:159], v[64:67]
    v_mfma_f32_16x16x32_bf16 v[68:71], v[180:183], v[156:159], v[68:71]
    ds_read_b128 v[220:223], v18 offset:23552
    v_mfma_f32_16x16x32_bf16 v[72:75], v[184:187], v[156:159], v[72:75]
    v_mfma_f32_16x16x32_bf16 v[76:79], v[188:191], v[156:159], v[76:79]
    ds_read_b128 v[224:227], v18 offset:24576
    s_waitcnt lgkmcnt(9)
    v_mfma_f32_16x16x32_bf16 v[80:83], v[168:171], v[160:163], v[80:83]
    v_mfma_f32_16x16x32_bf16 v[84:87], v[172:175], v[160:163], v[84:87]
    ds_read_b128 v[228:231], v18 offset:25600
    v_mfma_f32_16x16x32_bf16 v[88:91], v[176:179], v[160:163], v[88:91]
    v_mfma_f32_16x16x32_bf16 v[92:95], v[180:183], v[160:163], v[92:95]
    ds_read_b64 v[196:197], v12 offset:20480
    ds_read_b64 v[198:199], v12 offset:24576
    v_mfma_f32_16x16x32_bf16 v[96:99], v[184:187], v[160:163], v[96:99]
    v_mfma_f32_16x16x32_bf16 v[100:103], v[188:191], v[160:163], v[100:103]
    ds_read_b64 v[200:201], v15 offset:20736
    ds_read_b64 v[202:203], v15 offset:24832
    s_waitcnt lgkmcnt(12)
    v_mfma_f32_16x16x32_bf16 v[104:107], v[168:171], v[164:167], v[104:107]
    v_mfma_f32_16x16x32_bf16 v[108:111], v[172:175], v[164:167], v[108:111]
    ds_read_b64 v[204:205], v12 offset:20736
    ds_read_b64 v[206:207], v12 offset:24832
    v_mfma_f32_16x16x32_bf16 v[112:115], v[176:179], v[164:167], v[112:115]
    v_mfma_f32_16x16x32_bf16 v[116:119], v[180:183], v[164:167], v[116:119]
    v_mfma_f32_16x16x32_bf16 v[120:123], v[184:187], v[164:167], v[120:123]
    v_mfma_f32_16x16x32_bf16 v[124:127], v[188:191], v[164:167], v[124:127]
    s_waitcnt lgkmcnt(11)
    v_mfma_f32_16x16x32_bf16 v[32:35], v[208:211], v[192:195], v[32:35]
    s_waitcnt lgkmcnt(10)
    v_mfma_f32_16x16x32_bf16 v[36:39], v[212:215], v[192:195], v[36:39]
    s_barrier
    ds_read_b128 v[168:171], v17 offset:0
    s_waitcnt lgkmcnt(10)
    v_mfma_f32_16x16x32_bf16 v[40:43], v[216:219], v[192:195], v[40:43]
    s_waitcnt lgkmcnt(9)
    v_mfma_f32_16x16x32_bf16 v[44:47], v[220:223], v[192:195], v[44:47]
    ds_read_b64 v[152:153], v14 offset:0
    ds_read_b64 v[154:155], v14 offset:4096
    s_waitcnt lgkmcnt(10)
    v_mfma_f32_16x16x32_bf16 v[48:51], v[224:227], v[192:195], v[48:51]
    s_waitcnt lgkmcnt(9)
    v_mfma_f32_16x16x32_bf16 v[52:55], v[228:231], v[192:195], v[52:55]
    ds_read_b128 v[172:175], v17 offset:1024
    s_waitcnt lgkmcnt(8)
    v_mfma_f32_16x16x32_bf16 v[56:59], v[208:211], v[196:199], v[56:59]
    v_mfma_f32_16x16x32_bf16 v[60:63], v[212:215], v[196:199], v[60:63]
    ds_read_b128 v[176:179], v17 offset:2048
    v_mfma_f32_16x16x32_bf16 v[64:67], v[216:219], v[196:199], v[64:67]
    v_mfma_f32_16x16x32_bf16 v[68:71], v[220:223], v[196:199], v[68:71]
    ds_read_b128 v[180:183], v17 offset:3072
    v_mfma_f32_16x16x32_bf16 v[72:75], v[224:227], v[196:199], v[72:75]
    v_mfma_f32_16x16x32_bf16 v[76:79], v[228:231], v[196:199], v[76:79]
    ds_read_b128 v[184:187], v17 offset:4096
    s_waitcnt lgkmcnt(9)
    v_mfma_f32_16x16x32_bf16 v[80:83], v[208:211], v[200:203], v[80:83]
    v_mfma_f32_16x16x32_bf16 v[84:87], v[212:215], v[200:203], v[84:87]
    ds_read_b128 v[188:191], v17 offset:5120
    v_mfma_f32_16x16x32_bf16 v[88:91], v[216:219], v[200:203], v[88:91]
    v_mfma_f32_16x16x32_bf16 v[92:95], v[220:223], v[200:203], v[92:95]
    ds_read_b64 v[156:157], v1 offset:0
    ds_read_b64 v[158:159], v1 offset:4096
    v_mfma_f32_16x16x32_bf16 v[96:99], v[224:227], v[200:203], v[96:99]
    v_mfma_f32_16x16x32_bf16 v[100:103], v[228:231], v[200:203], v[100:103]
    ds_read_b64 v[160:161], v14 offset:256
    ds_read_b64 v[162:163], v14 offset:4352
    s_waitcnt lgkmcnt(12)
    v_mfma_f32_16x16x32_bf16 v[104:107], v[208:211], v[204:207], v[104:107]
    v_mfma_f32_16x16x32_bf16 v[108:111], v[212:215], v[204:207], v[108:111]
    ds_read_b64 v[164:165], v1 offset:256
    ds_read_b64 v[166:167], v1 offset:4352
    v_mfma_f32_16x16x32_bf16 v[112:115], v[216:219], v[204:207], v[112:115]
    v_mfma_f32_16x16x32_bf16 v[116:119], v[220:223], v[204:207], v[116:119]
    v_mfma_f32_16x16x32_bf16 v[120:123], v[224:227], v[204:207], v[120:123]
    v_mfma_f32_16x16x32_bf16 v[124:127], v[228:231], v[204:207], v[124:127]
    s_waitcnt lgkmcnt(11)
    v_mfma_f32_16x16x32_bf16 v[32:35], v[168:171], v[152:155], v[32:35]
    s_waitcnt lgkmcnt(10)
    v_mfma_f32_16x16x32_bf16 v[36:39], v[172:175], v[152:155], v[36:39]
    s_barrier
    ds_read_b128 v[208:211], v17 offset:20480
    s_waitcnt lgkmcnt(10)
    v_mfma_f32_16x16x32_bf16 v[40:43], v[176:179], v[152:155], v[40:43]
    s_waitcnt lgkmcnt(9)
    v_mfma_f32_16x16x32_bf16 v[44:47], v[180:183], v[152:155], v[44:47]
    ds_read_b64 v[192:193], v14 offset:20480
    ds_read_b64 v[194:195], v14 offset:24576
    s_waitcnt lgkmcnt(10)
    v_mfma_f32_16x16x32_bf16 v[48:51], v[184:187], v[152:155], v[48:51]
    s_waitcnt lgkmcnt(9)
    v_mfma_f32_16x16x32_bf16 v[52:55], v[188:191], v[152:155], v[52:55]
    ds_read_b128 v[212:215], v17 offset:21504
    s_waitcnt lgkmcnt(8)
    v_mfma_f32_16x16x32_bf16 v[56:59], v[168:171], v[156:159], v[56:59]
    v_mfma_f32_16x16x32_bf16 v[60:63], v[172:175], v[156:159], v[60:63]
    ds_read_b128 v[216:219], v17 offset:22528
    v_mfma_f32_16x16x32_bf16 v[64:67], v[176:179], v[156:159], v[64:67]
    v_mfma_f32_16x16x32_bf16 v[68:71], v[180:183], v[156:159], v[68:71]
    ds_read_b128 v[220:223], v17 offset:23552
    v_mfma_f32_16x16x32_bf16 v[72:75], v[184:187], v[156:159], v[72:75]
    v_mfma_f32_16x16x32_bf16 v[76:79], v[188:191], v[156:159], v[76:79]
    ds_read_b128 v[224:227], v17 offset:24576
    s_waitcnt lgkmcnt(9)
    v_mfma_f32_16x16x32_bf16 v[80:83], v[168:171], v[160:163], v[80:83]
    v_mfma_f32_16x16x32_bf16 v[84:87], v[172:175], v[160:163], v[84:87]
    ds_read_b128 v[228:231], v17 offset:25600
    v_mfma_f32_16x16x32_bf16 v[88:91], v[176:179], v[160:163], v[88:91]
    v_mfma_f32_16x16x32_bf16 v[92:95], v[180:183], v[160:163], v[92:95]
    ds_read_b64 v[196:197], v1 offset:20480
    ds_read_b64 v[198:199], v1 offset:24576
    v_mfma_f32_16x16x32_bf16 v[96:99], v[184:187], v[160:163], v[96:99]
    v_mfma_f32_16x16x32_bf16 v[100:103], v[188:191], v[160:163], v[100:103]
    ds_read_b64 v[200:201], v14 offset:20736
    ds_read_b64 v[202:203], v14 offset:24832
    s_waitcnt lgkmcnt(12)
    v_mfma_f32_16x16x32_bf16 v[104:107], v[168:171], v[164:167], v[104:107]
    v_mfma_f32_16x16x32_bf16 v[108:111], v[172:175], v[164:167], v[108:111]
    ds_read_b64 v[204:205], v1 offset:20736
    ds_read_b64 v[206:207], v1 offset:24832
    v_mfma_f32_16x16x32_bf16 v[112:115], v[176:179], v[164:167], v[112:115]
    v_mfma_f32_16x16x32_bf16 v[116:119], v[180:183], v[164:167], v[116:119]
    v_mfma_f32_16x16x32_bf16 v[120:123], v[184:187], v[164:167], v[120:123]
    v_mfma_f32_16x16x32_bf16 v[124:127], v[188:191], v[164:167], v[124:127]
    s_waitcnt lgkmcnt(11)
    v_mfma_f32_16x16x32_bf16 v[32:35], v[208:211], v[192:195], v[32:35]
    s_waitcnt lgkmcnt(10)
    v_mfma_f32_16x16x32_bf16 v[36:39], v[212:215], v[192:195], v[36:39]
    s_barrier
    ds_read_b128 v[168:171], v17 offset:40960
    s_waitcnt lgkmcnt(10)
    v_mfma_f32_16x16x32_bf16 v[40:43], v[216:219], v[192:195], v[40:43]
    s_waitcnt lgkmcnt(9)
    v_mfma_f32_16x16x32_bf16 v[44:47], v[220:223], v[192:195], v[44:47]
    ds_read_b64 v[152:153], v14 offset:40960
    ds_read_b64 v[154:155], v14 offset:45056
    s_waitcnt lgkmcnt(10)
    v_mfma_f32_16x16x32_bf16 v[48:51], v[224:227], v[192:195], v[48:51]
    s_waitcnt lgkmcnt(9)
    v_mfma_f32_16x16x32_bf16 v[52:55], v[228:231], v[192:195], v[52:55]
    ds_read_b128 v[172:175], v17 offset:41984
    s_waitcnt lgkmcnt(8)
    v_mfma_f32_16x16x32_bf16 v[56:59], v[208:211], v[196:199], v[56:59]
    v_mfma_f32_16x16x32_bf16 v[60:63], v[212:215], v[196:199], v[60:63]
    ds_read_b128 v[176:179], v17 offset:43008
    v_mfma_f32_16x16x32_bf16 v[64:67], v[216:219], v[196:199], v[64:67]
    v_mfma_f32_16x16x32_bf16 v[68:71], v[220:223], v[196:199], v[68:71]
    ds_read_b128 v[180:183], v17 offset:44032
    v_mfma_f32_16x16x32_bf16 v[72:75], v[224:227], v[196:199], v[72:75]
    v_mfma_f32_16x16x32_bf16 v[76:79], v[228:231], v[196:199], v[76:79]
    ds_read_b128 v[184:187], v17 offset:45056
    s_waitcnt lgkmcnt(9)
    v_mfma_f32_16x16x32_bf16 v[80:83], v[208:211], v[200:203], v[80:83]
    v_mfma_f32_16x16x32_bf16 v[84:87], v[212:215], v[200:203], v[84:87]
    ds_read_b128 v[188:191], v17 offset:46080
    v_mfma_f32_16x16x32_bf16 v[88:91], v[216:219], v[200:203], v[88:91]
    v_mfma_f32_16x16x32_bf16 v[92:95], v[220:223], v[200:203], v[92:95]
    ds_read_b64 v[156:157], v1 offset:40960
    ds_read_b64 v[158:159], v1 offset:45056
    v_mfma_f32_16x16x32_bf16 v[96:99], v[224:227], v[200:203], v[96:99]
    v_mfma_f32_16x16x32_bf16 v[100:103], v[228:231], v[200:203], v[100:103]
    ds_read_b64 v[160:161], v14 offset:41216
    ds_read_b64 v[162:163], v14 offset:45312
    s_waitcnt lgkmcnt(12)
    v_mfma_f32_16x16x32_bf16 v[104:107], v[208:211], v[204:207], v[104:107]
    v_mfma_f32_16x16x32_bf16 v[108:111], v[212:215], v[204:207], v[108:111]
    ds_read_b64 v[164:165], v1 offset:41216
    ds_read_b64 v[166:167], v1 offset:45312
    v_mfma_f32_16x16x32_bf16 v[112:115], v[216:219], v[204:207], v[112:115]
    v_mfma_f32_16x16x32_bf16 v[116:119], v[220:223], v[204:207], v[116:119]
    v_mfma_f32_16x16x32_bf16 v[120:123], v[224:227], v[204:207], v[120:123]
    v_mfma_f32_16x16x32_bf16 v[124:127], v[228:231], v[204:207], v[124:127]
    s_waitcnt lgkmcnt(11)
    v_mfma_f32_16x16x32_bf16 v[32:35], v[168:171], v[152:155], v[32:35]
    s_waitcnt lgkmcnt(10)
    v_mfma_f32_16x16x32_bf16 v[36:39], v[172:175], v[152:155], v[36:39]
    s_barrier
    ds_read_b128 v[208:211], v18 offset:0
    s_waitcnt lgkmcnt(10)
    v_mfma_f32_16x16x32_bf16 v[40:43], v[176:179], v[152:155], v[40:43]
    s_waitcnt lgkmcnt(9)
    v_mfma_f32_16x16x32_bf16 v[44:47], v[180:183], v[152:155], v[44:47]
    ds_read_b64 v[192:193], v15 offset:0
    ds_read_b64 v[194:195], v15 offset:4096
    s_waitcnt lgkmcnt(10)
    v_mfma_f32_16x16x32_bf16 v[48:51], v[184:187], v[152:155], v[48:51]
    s_waitcnt lgkmcnt(9)
    v_mfma_f32_16x16x32_bf16 v[52:55], v[188:191], v[152:155], v[52:55]
    ds_read_b128 v[212:215], v18 offset:1024
    s_waitcnt lgkmcnt(8)
    v_mfma_f32_16x16x32_bf16 v[56:59], v[168:171], v[156:159], v[56:59]
    v_mfma_f32_16x16x32_bf16 v[60:63], v[172:175], v[156:159], v[60:63]
    ds_read_b128 v[216:219], v18 offset:2048
    v_mfma_f32_16x16x32_bf16 v[64:67], v[176:179], v[156:159], v[64:67]
    v_mfma_f32_16x16x32_bf16 v[68:71], v[180:183], v[156:159], v[68:71]
    ds_read_b128 v[220:223], v18 offset:3072
    v_mfma_f32_16x16x32_bf16 v[72:75], v[184:187], v[156:159], v[72:75]
    v_mfma_f32_16x16x32_bf16 v[76:79], v[188:191], v[156:159], v[76:79]
    ds_read_b128 v[224:227], v18 offset:4096
    s_waitcnt lgkmcnt(9)
    v_mfma_f32_16x16x32_bf16 v[80:83], v[168:171], v[160:163], v[80:83]
    v_mfma_f32_16x16x32_bf16 v[84:87], v[172:175], v[160:163], v[84:87]
    ds_read_b128 v[228:231], v18 offset:5120
    v_mfma_f32_16x16x32_bf16 v[88:91], v[176:179], v[160:163], v[88:91]
    v_mfma_f32_16x16x32_bf16 v[92:95], v[180:183], v[160:163], v[92:95]
    ds_read_b64 v[196:197], v12 offset:0
    ds_read_b64 v[198:199], v12 offset:4096
    v_mfma_f32_16x16x32_bf16 v[96:99], v[184:187], v[160:163], v[96:99]
    v_mfma_f32_16x16x32_bf16 v[100:103], v[188:191], v[160:163], v[100:103]
    ds_read_b64 v[200:201], v15 offset:256
    ds_read_b64 v[202:203], v15 offset:4352
    s_waitcnt lgkmcnt(12)
    v_mfma_f32_16x16x32_bf16 v[104:107], v[168:171], v[164:167], v[104:107]
    v_mfma_f32_16x16x32_bf16 v[108:111], v[172:175], v[164:167], v[108:111]
    ds_read_b64 v[204:205], v12 offset:256
    ds_read_b64 v[206:207], v12 offset:4352
    v_mfma_f32_16x16x32_bf16 v[112:115], v[176:179], v[164:167], v[112:115]
    v_mfma_f32_16x16x32_bf16 v[116:119], v[180:183], v[164:167], v[116:119]
    v_mfma_f32_16x16x32_bf16 v[120:123], v[184:187], v[164:167], v[120:123]
    v_mfma_f32_16x16x32_bf16 v[124:127], v[188:191], v[164:167], v[124:127]
    s_waitcnt lgkmcnt(11)
    v_mfma_f32_16x16x32_bf16 v[32:35], v[208:211], v[192:195], v[32:35]
    s_waitcnt lgkmcnt(10)
    v_mfma_f32_16x16x32_bf16 v[36:39], v[212:215], v[192:195], v[36:39]
    s_barrier
    ds_read_b128 v[168:171], v18 offset:20480
    s_waitcnt lgkmcnt(10)
    v_mfma_f32_16x16x32_bf16 v[40:43], v[216:219], v[192:195], v[40:43]
    s_waitcnt lgkmcnt(9)
    v_mfma_f32_16x16x32_bf16 v[44:47], v[220:223], v[192:195], v[44:47]
    ds_read_b64 v[152:153], v15 offset:20480
    ds_read_b64 v[154:155], v15 offset:24576
    s_waitcnt lgkmcnt(10)
    v_mfma_f32_16x16x32_bf16 v[48:51], v[224:227], v[192:195], v[48:51]
    s_waitcnt lgkmcnt(9)
    v_mfma_f32_16x16x32_bf16 v[52:55], v[228:231], v[192:195], v[52:55]
    ds_read_b128 v[172:175], v18 offset:21504
    s_waitcnt lgkmcnt(8)
    v_mfma_f32_16x16x32_bf16 v[56:59], v[208:211], v[196:199], v[56:59]
    v_mfma_f32_16x16x32_bf16 v[60:63], v[212:215], v[196:199], v[60:63]
    ds_read_b128 v[176:179], v18 offset:22528
    v_mfma_f32_16x16x32_bf16 v[64:67], v[216:219], v[196:199], v[64:67]
    v_mfma_f32_16x16x32_bf16 v[68:71], v[220:223], v[196:199], v[68:71]
    ds_read_b128 v[180:183], v18 offset:23552
    v_mfma_f32_16x16x32_bf16 v[72:75], v[224:227], v[196:199], v[72:75]
    v_mfma_f32_16x16x32_bf16 v[76:79], v[228:231], v[196:199], v[76:79]
    ds_read_b128 v[184:187], v18 offset:24576
    s_waitcnt lgkmcnt(9)
    v_mfma_f32_16x16x32_bf16 v[80:83], v[208:211], v[200:203], v[80:83]
    v_mfma_f32_16x16x32_bf16 v[84:87], v[212:215], v[200:203], v[84:87]
    ds_read_b128 v[188:191], v18 offset:25600
    v_mfma_f32_16x16x32_bf16 v[88:91], v[216:219], v[200:203], v[88:91]
    v_mfma_f32_16x16x32_bf16 v[92:95], v[220:223], v[200:203], v[92:95]
    ds_read_b64 v[156:157], v12 offset:20480
    ds_read_b64 v[158:159], v12 offset:24576
    v_mfma_f32_16x16x32_bf16 v[96:99], v[224:227], v[200:203], v[96:99]
    v_mfma_f32_16x16x32_bf16 v[100:103], v[228:231], v[200:203], v[100:103]
    ds_read_b64 v[160:161], v15 offset:20736
    ds_read_b64 v[162:163], v15 offset:24832
    s_waitcnt lgkmcnt(12)
    v_mfma_f32_16x16x32_bf16 v[104:107], v[208:211], v[204:207], v[104:107]
    v_mfma_f32_16x16x32_bf16 v[108:111], v[212:215], v[204:207], v[108:111]
    ds_read_b64 v[164:165], v12 offset:20736
    ds_read_b64 v[166:167], v12 offset:24832
    v_mfma_f32_16x16x32_bf16 v[112:115], v[216:219], v[204:207], v[112:115]
    v_mfma_f32_16x16x32_bf16 v[116:119], v[220:223], v[204:207], v[116:119]
    v_mfma_f32_16x16x32_bf16 v[120:123], v[224:227], v[204:207], v[120:123]
    v_mfma_f32_16x16x32_bf16 v[124:127], v[228:231], v[204:207], v[124:127]
    s_waitcnt lgkmcnt(11)
    v_mfma_f32_16x16x32_bf16 v[32:35], v[168:171], v[152:155], v[32:35]
    s_waitcnt lgkmcnt(10)
    v_mfma_f32_16x16x32_bf16 v[36:39], v[172:175], v[152:155], v[36:39]
    s_barrier
    ds_read_b128 v[208:211], v17 offset:0
    s_waitcnt lgkmcnt(10)
    v_mfma_f32_16x16x32_bf16 v[40:43], v[176:179], v[152:155], v[40:43]
    s_waitcnt lgkmcnt(9)
    v_mfma_f32_16x16x32_bf16 v[44:47], v[180:183], v[152:155], v[44:47]
    ds_read_b64 v[192:193], v14 offset:0
    ds_read_b64 v[194:195], v14 offset:4096
    s_waitcnt lgkmcnt(10)
    v_mfma_f32_16x16x32_bf16 v[48:51], v[184:187], v[152:155], v[48:51]
    s_waitcnt lgkmcnt(9)
    v_mfma_f32_16x16x32_bf16 v[52:55], v[188:191], v[152:155], v[52:55]
    ds_read_b128 v[212:215], v17 offset:1024
    s_waitcnt lgkmcnt(8)
    v_mfma_f32_16x16x32_bf16 v[56:59], v[168:171], v[156:159], v[56:59]
    v_mfma_f32_16x16x32_bf16 v[60:63], v[172:175], v[156:159], v[60:63]
    ds_read_b128 v[216:219], v17 offset:2048
    v_mfma_f32_16x16x32_bf16 v[64:67], v[176:179], v[156:159], v[64:67]
    v_mfma_f32_16x16x32_bf16 v[68:71], v[180:183], v[156:159], v[68:71]
    ds_read_b128 v[220:223], v17 offset:3072
    v_mfma_f32_16x16x32_bf16 v[72:75], v[184:187], v[156:159], v[72:75]
    v_mfma_f32_16x16x32_bf16 v[76:79], v[188:191], v[156:159], v[76:79]
    ds_read_b128 v[224:227], v17 offset:4096
    s_waitcnt lgkmcnt(9)
    v_mfma_f32_16x16x32_bf16 v[80:83], v[168:171], v[160:163], v[80:83]
    v_mfma_f32_16x16x32_bf16 v[84:87], v[172:175], v[160:163], v[84:87]
    ds_read_b128 v[228:231], v17 offset:5120
    v_mfma_f32_16x16x32_bf16 v[88:91], v[176:179], v[160:163], v[88:91]
    v_mfma_f32_16x16x32_bf16 v[92:95], v[180:183], v[160:163], v[92:95]
    ds_read_b64 v[196:197], v1 offset:0
    ds_read_b64 v[198:199], v1 offset:4096
    v_mfma_f32_16x16x32_bf16 v[96:99], v[184:187], v[160:163], v[96:99]
    v_mfma_f32_16x16x32_bf16 v[100:103], v[188:191], v[160:163], v[100:103]
    ds_read_b64 v[200:201], v14 offset:256
    ds_read_b64 v[202:203], v14 offset:4352
    s_waitcnt lgkmcnt(12)
    v_mfma_f32_16x16x32_bf16 v[104:107], v[168:171], v[164:167], v[104:107]
    v_mfma_f32_16x16x32_bf16 v[108:111], v[172:175], v[164:167], v[108:111]
    ds_read_b64 v[204:205], v1 offset:256
    ds_read_b64 v[206:207], v1 offset:4352
    v_mfma_f32_16x16x32_bf16 v[112:115], v[176:179], v[164:167], v[112:115]
    v_mfma_f32_16x16x32_bf16 v[116:119], v[180:183], v[164:167], v[116:119]
    v_mfma_f32_16x16x32_bf16 v[120:123], v[184:187], v[164:167], v[120:123]
    v_mfma_f32_16x16x32_bf16 v[124:127], v[188:191], v[164:167], v[124:127]
    s_waitcnt lgkmcnt(11)
    v_mfma_f32_16x16x32_bf16 v[32:35], v[208:211], v[192:195], v[32:35]
    s_waitcnt lgkmcnt(10)
    v_mfma_f32_16x16x32_bf16 v[36:39], v[212:215], v[192:195], v[36:39]
    s_barrier
    ds_read_b128 v[168:171], v17 offset:20480
    s_waitcnt lgkmcnt(10)
    v_mfma_f32_16x16x32_bf16 v[40:43], v[216:219], v[192:195], v[40:43]
    s_waitcnt lgkmcnt(9)
    v_mfma_f32_16x16x32_bf16 v[44:47], v[220:223], v[192:195], v[44:47]
    ds_read_b64 v[152:153], v14 offset:20480
    ds_read_b64 v[154:155], v14 offset:24576
    s_waitcnt lgkmcnt(10)
    v_mfma_f32_16x16x32_bf16 v[48:51], v[224:227], v[192:195], v[48:51]
    s_waitcnt lgkmcnt(9)
    v_mfma_f32_16x16x32_bf16 v[52:55], v[228:231], v[192:195], v[52:55]
    ds_read_b128 v[172:175], v17 offset:21504
    s_waitcnt lgkmcnt(8)
    v_mfma_f32_16x16x32_bf16 v[56:59], v[208:211], v[196:199], v[56:59]
    v_mfma_f32_16x16x32_bf16 v[60:63], v[212:215], v[196:199], v[60:63]
    ds_read_b128 v[176:179], v17 offset:22528
    v_mfma_f32_16x16x32_bf16 v[64:67], v[216:219], v[196:199], v[64:67]
    v_mfma_f32_16x16x32_bf16 v[68:71], v[220:223], v[196:199], v[68:71]
    ds_read_b128 v[180:183], v17 offset:23552
    v_mfma_f32_16x16x32_bf16 v[72:75], v[224:227], v[196:199], v[72:75]
    v_mfma_f32_16x16x32_bf16 v[76:79], v[228:231], v[196:199], v[76:79]
    ds_read_b128 v[184:187], v17 offset:24576
    s_waitcnt lgkmcnt(9)
    v_mfma_f32_16x16x32_bf16 v[80:83], v[208:211], v[200:203], v[80:83]
    v_mfma_f32_16x16x32_bf16 v[84:87], v[212:215], v[200:203], v[84:87]
    ds_read_b128 v[188:191], v17 offset:25600
    v_mfma_f32_16x16x32_bf16 v[88:91], v[216:219], v[200:203], v[88:91]
    v_mfma_f32_16x16x32_bf16 v[92:95], v[220:223], v[200:203], v[92:95]
    ds_read_b64 v[156:157], v1 offset:20480
    ds_read_b64 v[158:159], v1 offset:24576
    v_mfma_f32_16x16x32_bf16 v[96:99], v[224:227], v[200:203], v[96:99]
    v_mfma_f32_16x16x32_bf16 v[100:103], v[228:231], v[200:203], v[100:103]
    ds_read_b64 v[160:161], v14 offset:20736
    ds_read_b64 v[162:163], v14 offset:24832
    s_waitcnt lgkmcnt(12)
    v_mfma_f32_16x16x32_bf16 v[104:107], v[208:211], v[204:207], v[104:107]
    v_mfma_f32_16x16x32_bf16 v[108:111], v[212:215], v[204:207], v[108:111]
    ds_read_b64 v[164:165], v1 offset:20736
    ds_read_b64 v[166:167], v1 offset:24832
    v_mfma_f32_16x16x32_bf16 v[112:115], v[216:219], v[204:207], v[112:115]
    v_mfma_f32_16x16x32_bf16 v[116:119], v[220:223], v[204:207], v[116:119]
    v_mfma_f32_16x16x32_bf16 v[120:123], v[224:227], v[204:207], v[120:123]
    v_mfma_f32_16x16x32_bf16 v[124:127], v[228:231], v[204:207], v[124:127]
    s_waitcnt lgkmcnt(11)
    v_mfma_f32_16x16x32_bf16 v[32:35], v[168:171], v[152:155], v[32:35]
    s_waitcnt lgkmcnt(10)
    v_mfma_f32_16x16x32_bf16 v[36:39], v[172:175], v[152:155], v[36:39]
    s_barrier
    ds_read_b128 v[208:211], v17 offset:40960
    s_waitcnt lgkmcnt(10)
    v_mfma_f32_16x16x32_bf16 v[40:43], v[176:179], v[152:155], v[40:43]
    s_waitcnt lgkmcnt(9)
    v_mfma_f32_16x16x32_bf16 v[44:47], v[180:183], v[152:155], v[44:47]
    ds_read_b64 v[192:193], v14 offset:40960
    ds_read_b64 v[194:195], v14 offset:45056
    s_waitcnt lgkmcnt(10)
    v_mfma_f32_16x16x32_bf16 v[48:51], v[184:187], v[152:155], v[48:51]
    s_waitcnt lgkmcnt(9)
    v_mfma_f32_16x16x32_bf16 v[52:55], v[188:191], v[152:155], v[52:55]
    ds_read_b128 v[212:215], v17 offset:41984
    s_waitcnt lgkmcnt(8)
    v_mfma_f32_16x16x32_bf16 v[56:59], v[168:171], v[156:159], v[56:59]
    v_mfma_f32_16x16x32_bf16 v[60:63], v[172:175], v[156:159], v[60:63]
    ds_read_b128 v[216:219], v17 offset:43008
    v_mfma_f32_16x16x32_bf16 v[64:67], v[176:179], v[156:159], v[64:67]
    v_mfma_f32_16x16x32_bf16 v[68:71], v[180:183], v[156:159], v[68:71]
    ds_read_b128 v[220:223], v17 offset:44032
    v_mfma_f32_16x16x32_bf16 v[72:75], v[184:187], v[156:159], v[72:75]
    v_mfma_f32_16x16x32_bf16 v[76:79], v[188:191], v[156:159], v[76:79]
    ds_read_b128 v[224:227], v17 offset:45056
    s_waitcnt lgkmcnt(9)
    v_mfma_f32_16x16x32_bf16 v[80:83], v[168:171], v[160:163], v[80:83]
    v_mfma_f32_16x16x32_bf16 v[84:87], v[172:175], v[160:163], v[84:87]
    ds_read_b128 v[228:231], v17 offset:46080
    v_mfma_f32_16x16x32_bf16 v[88:91], v[176:179], v[160:163], v[88:91]
    v_mfma_f32_16x16x32_bf16 v[92:95], v[180:183], v[160:163], v[92:95]
    ds_read_b64 v[196:197], v1 offset:40960
    ds_read_b64 v[198:199], v1 offset:45056
    v_mfma_f32_16x16x32_bf16 v[96:99], v[184:187], v[160:163], v[96:99]
    v_mfma_f32_16x16x32_bf16 v[100:103], v[188:191], v[160:163], v[100:103]
    ds_read_b64 v[200:201], v14 offset:41216
    ds_read_b64 v[202:203], v14 offset:45312
    s_waitcnt lgkmcnt(12)
    v_mfma_f32_16x16x32_bf16 v[104:107], v[168:171], v[164:167], v[104:107]
    v_mfma_f32_16x16x32_bf16 v[108:111], v[172:175], v[164:167], v[108:111]
    ds_read_b64 v[204:205], v1 offset:41216
    ds_read_b64 v[206:207], v1 offset:45312
    v_mfma_f32_16x16x32_bf16 v[112:115], v[176:179], v[164:167], v[112:115]
    v_mfma_f32_16x16x32_bf16 v[116:119], v[180:183], v[164:167], v[116:119]
    v_mfma_f32_16x16x32_bf16 v[120:123], v[184:187], v[164:167], v[120:123]
    v_mfma_f32_16x16x32_bf16 v[124:127], v[188:191], v[164:167], v[124:127]
    s_waitcnt lgkmcnt(11)
    v_mfma_f32_16x16x32_bf16 v[32:35], v[208:211], v[192:195], v[32:35]
    s_waitcnt lgkmcnt(10)
    v_mfma_f32_16x16x32_bf16 v[36:39], v[212:215], v[192:195], v[36:39]
    s_barrier
    ds_read_b128 v[168:171], v18 offset:0
    s_waitcnt lgkmcnt(10)
    v_mfma_f32_16x16x32_bf16 v[40:43], v[216:219], v[192:195], v[40:43]
    s_waitcnt lgkmcnt(9)
    v_mfma_f32_16x16x32_bf16 v[44:47], v[220:223], v[192:195], v[44:47]
    ds_read_b64 v[152:153], v15 offset:0
    ds_read_b64 v[154:155], v15 offset:4096
    s_waitcnt lgkmcnt(10)
    v_mfma_f32_16x16x32_bf16 v[48:51], v[224:227], v[192:195], v[48:51]
    s_waitcnt lgkmcnt(9)
    v_mfma_f32_16x16x32_bf16 v[52:55], v[228:231], v[192:195], v[52:55]
    ds_read_b128 v[172:175], v18 offset:1024
    s_waitcnt lgkmcnt(8)
    v_mfma_f32_16x16x32_bf16 v[56:59], v[208:211], v[196:199], v[56:59]
    v_mfma_f32_16x16x32_bf16 v[60:63], v[212:215], v[196:199], v[60:63]
    ds_read_b128 v[176:179], v18 offset:2048
    v_mfma_f32_16x16x32_bf16 v[64:67], v[216:219], v[196:199], v[64:67]
    v_mfma_f32_16x16x32_bf16 v[68:71], v[220:223], v[196:199], v[68:71]
    ds_read_b128 v[180:183], v18 offset:3072
    v_mfma_f32_16x16x32_bf16 v[72:75], v[224:227], v[196:199], v[72:75]
    v_mfma_f32_16x16x32_bf16 v[76:79], v[228:231], v[196:199], v[76:79]
    ds_read_b128 v[184:187], v18 offset:4096
    s_waitcnt lgkmcnt(9)
    v_mfma_f32_16x16x32_bf16 v[80:83], v[208:211], v[200:203], v[80:83]
    v_mfma_f32_16x16x32_bf16 v[84:87], v[212:215], v[200:203], v[84:87]
    ds_read_b128 v[188:191], v18 offset:5120
    v_mfma_f32_16x16x32_bf16 v[88:91], v[216:219], v[200:203], v[88:91]
    v_mfma_f32_16x16x32_bf16 v[92:95], v[220:223], v[200:203], v[92:95]
    ds_read_b64 v[156:157], v12 offset:0
    ds_read_b64 v[158:159], v12 offset:4096
    v_mfma_f32_16x16x32_bf16 v[96:99], v[224:227], v[200:203], v[96:99]
    v_mfma_f32_16x16x32_bf16 v[100:103], v[228:231], v[200:203], v[100:103]
    ds_read_b64 v[160:161], v15 offset:256
    ds_read_b64 v[162:163], v15 offset:4352
    s_waitcnt lgkmcnt(12)
    v_mfma_f32_16x16x32_bf16 v[104:107], v[208:211], v[204:207], v[104:107]
    v_mfma_f32_16x16x32_bf16 v[108:111], v[212:215], v[204:207], v[108:111]
    ds_read_b64 v[164:165], v12 offset:256
    ds_read_b64 v[166:167], v12 offset:4352
    v_mfma_f32_16x16x32_bf16 v[112:115], v[216:219], v[204:207], v[112:115]
    v_mfma_f32_16x16x32_bf16 v[116:119], v[220:223], v[204:207], v[116:119]
    v_mfma_f32_16x16x32_bf16 v[120:123], v[224:227], v[204:207], v[120:123]
    v_mfma_f32_16x16x32_bf16 v[124:127], v[228:231], v[204:207], v[124:127]
    s_waitcnt lgkmcnt(11)
    v_mfma_f32_16x16x32_bf16 v[32:35], v[168:171], v[152:155], v[32:35]
    s_waitcnt lgkmcnt(10)
    v_mfma_f32_16x16x32_bf16 v[36:39], v[172:175], v[152:155], v[36:39]
    s_barrier
    ds_read_b128 v[208:211], v18 offset:20480
    s_waitcnt lgkmcnt(10)
    v_mfma_f32_16x16x32_bf16 v[40:43], v[176:179], v[152:155], v[40:43]
    s_waitcnt lgkmcnt(9)
    v_mfma_f32_16x16x32_bf16 v[44:47], v[180:183], v[152:155], v[44:47]
    ds_read_b64 v[192:193], v15 offset:20480
    ds_read_b64 v[194:195], v15 offset:24576
    s_waitcnt lgkmcnt(10)
    v_mfma_f32_16x16x32_bf16 v[48:51], v[184:187], v[152:155], v[48:51]
    s_waitcnt lgkmcnt(9)
    v_mfma_f32_16x16x32_bf16 v[52:55], v[188:191], v[152:155], v[52:55]
    ds_read_b128 v[212:215], v18 offset:21504
    s_waitcnt lgkmcnt(8)
    v_mfma_f32_16x16x32_bf16 v[56:59], v[168:171], v[156:159], v[56:59]
    v_mfma_f32_16x16x32_bf16 v[60:63], v[172:175], v[156:159], v[60:63]
    ds_read_b128 v[216:219], v18 offset:22528
    v_mfma_f32_16x16x32_bf16 v[64:67], v[176:179], v[156:159], v[64:67]
    v_mfma_f32_16x16x32_bf16 v[68:71], v[180:183], v[156:159], v[68:71]
    ds_read_b128 v[220:223], v18 offset:23552
    v_mfma_f32_16x16x32_bf16 v[72:75], v[184:187], v[156:159], v[72:75]
    v_mfma_f32_16x16x32_bf16 v[76:79], v[188:191], v[156:159], v[76:79]
    ds_read_b128 v[224:227], v18 offset:24576
    s_waitcnt lgkmcnt(9)
    v_mfma_f32_16x16x32_bf16 v[80:83], v[168:171], v[160:163], v[80:83]
    v_mfma_f32_16x16x32_bf16 v[84:87], v[172:175], v[160:163], v[84:87]
    ds_read_b128 v[228:231], v18 offset:25600
    v_mfma_f32_16x16x32_bf16 v[88:91], v[176:179], v[160:163], v[88:91]
    v_mfma_f32_16x16x32_bf16 v[92:95], v[180:183], v[160:163], v[92:95]
    ds_read_b64 v[196:197], v12 offset:20480
    ds_read_b64 v[198:199], v12 offset:24576
    v_mfma_f32_16x16x32_bf16 v[96:99], v[184:187], v[160:163], v[96:99]
    v_mfma_f32_16x16x32_bf16 v[100:103], v[188:191], v[160:163], v[100:103]
    ds_read_b64 v[200:201], v15 offset:20736
    ds_read_b64 v[202:203], v15 offset:24832
    s_waitcnt lgkmcnt(12)
    v_mfma_f32_16x16x32_bf16 v[104:107], v[168:171], v[164:167], v[104:107]
    v_mfma_f32_16x16x32_bf16 v[108:111], v[172:175], v[164:167], v[108:111]
    ds_read_b64 v[204:205], v12 offset:20736
    ds_read_b64 v[206:207], v12 offset:24832
    v_mfma_f32_16x16x32_bf16 v[112:115], v[176:179], v[164:167], v[112:115]
    v_mfma_f32_16x16x32_bf16 v[116:119], v[180:183], v[164:167], v[116:119]
    v_mfma_f32_16x16x32_bf16 v[120:123], v[184:187], v[164:167], v[120:123]
    v_mfma_f32_16x16x32_bf16 v[124:127], v[188:191], v[164:167], v[124:127]
    s_waitcnt lgkmcnt(11)
    v_mfma_f32_16x16x32_bf16 v[32:35], v[208:211], v[192:195], v[32:35]
    s_waitcnt lgkmcnt(10)
    v_mfma_f32_16x16x32_bf16 v[36:39], v[212:215], v[192:195], v[36:39]
    s_barrier
    ds_read_b128 v[168:171], v17 offset:0
    s_waitcnt lgkmcnt(10)
    v_mfma_f32_16x16x32_bf16 v[40:43], v[216:219], v[192:195], v[40:43]
    s_waitcnt lgkmcnt(9)
    v_mfma_f32_16x16x32_bf16 v[44:47], v[220:223], v[192:195], v[44:47]
    ds_read_b64 v[152:153], v14 offset:0
    ds_read_b64 v[154:155], v14 offset:4096
    s_waitcnt lgkmcnt(10)
    v_mfma_f32_16x16x32_bf16 v[48:51], v[224:227], v[192:195], v[48:51]
    s_waitcnt lgkmcnt(9)
    v_mfma_f32_16x16x32_bf16 v[52:55], v[228:231], v[192:195], v[52:55]
    ds_read_b128 v[172:175], v17 offset:1024
    s_waitcnt lgkmcnt(8)
    v_mfma_f32_16x16x32_bf16 v[56:59], v[208:211], v[196:199], v[56:59]
    v_mfma_f32_16x16x32_bf16 v[60:63], v[212:215], v[196:199], v[60:63]
    ds_read_b128 v[176:179], v17 offset:2048
    v_mfma_f32_16x16x32_bf16 v[64:67], v[216:219], v[196:199], v[64:67]
    v_mfma_f32_16x16x32_bf16 v[68:71], v[220:223], v[196:199], v[68:71]
    ds_read_b128 v[180:183], v17 offset:3072
    v_mfma_f32_16x16x32_bf16 v[72:75], v[224:227], v[196:199], v[72:75]
    v_mfma_f32_16x16x32_bf16 v[76:79], v[228:231], v[196:199], v[76:79]
    ds_read_b128 v[184:187], v17 offset:4096
    s_waitcnt lgkmcnt(9)
    v_mfma_f32_16x16x32_bf16 v[80:83], v[208:211], v[200:203], v[80:83]
    v_mfma_f32_16x16x32_bf16 v[84:87], v[212:215], v[200:203], v[84:87]
    ds_read_b128 v[188:191], v17 offset:5120
    v_mfma_f32_16x16x32_bf16 v[88:91], v[216:219], v[200:203], v[88:91]
    v_mfma_f32_16x16x32_bf16 v[92:95], v[220:223], v[200:203], v[92:95]
    ds_read_b64 v[156:157], v1 offset:0
    ds_read_b64 v[158:159], v1 offset:4096
    v_mfma_f32_16x16x32_bf16 v[96:99], v[224:227], v[200:203], v[96:99]
    v_mfma_f32_16x16x32_bf16 v[100:103], v[228:231], v[200:203], v[100:103]
    ds_read_b64 v[160:161], v14 offset:256
    ds_read_b64 v[162:163], v14 offset:4352
    s_waitcnt lgkmcnt(12)
    v_mfma_f32_16x16x32_bf16 v[104:107], v[208:211], v[204:207], v[104:107]
    v_mfma_f32_16x16x32_bf16 v[108:111], v[212:215], v[204:207], v[108:111]
    ds_read_b64 v[164:165], v1 offset:256
    ds_read_b64 v[166:167], v1 offset:4352
    v_mfma_f32_16x16x32_bf16 v[112:115], v[216:219], v[204:207], v[112:115]
    v_mfma_f32_16x16x32_bf16 v[116:119], v[220:223], v[204:207], v[116:119]
    v_mfma_f32_16x16x32_bf16 v[120:123], v[224:227], v[204:207], v[120:123]
    v_mfma_f32_16x16x32_bf16 v[124:127], v[228:231], v[204:207], v[124:127]
    s_waitcnt lgkmcnt(11)
    v_mfma_f32_16x16x32_bf16 v[32:35], v[168:171], v[152:155], v[32:35]
    s_waitcnt lgkmcnt(10)
    v_mfma_f32_16x16x32_bf16 v[36:39], v[172:175], v[152:155], v[36:39]
    s_waitcnt lgkmcnt(9)
    v_mfma_f32_16x16x32_bf16 v[40:43], v[176:179], v[152:155], v[40:43]
    s_waitcnt lgkmcnt(8)
    v_mfma_f32_16x16x32_bf16 v[44:47], v[180:183], v[152:155], v[44:47]
    s_waitcnt lgkmcnt(7)
    v_mfma_f32_16x16x32_bf16 v[48:51], v[184:187], v[152:155], v[48:51]
    s_waitcnt lgkmcnt(6)
    v_mfma_f32_16x16x32_bf16 v[52:55], v[188:191], v[152:155], v[52:55]
    s_waitcnt lgkmcnt(4)
    v_mfma_f32_16x16x32_bf16 v[56:59], v[168:171], v[156:159], v[56:59]
    v_mfma_f32_16x16x32_bf16 v[60:63], v[172:175], v[156:159], v[60:63]
    v_mfma_f32_16x16x32_bf16 v[64:67], v[176:179], v[156:159], v[64:67]
    v_max_f32 v32, 0, v32
    v_max_f32 v33, 0, v33
    v_max_f32 v34, 0, v34
    v_mfma_f32_16x16x32_bf16 v[68:71], v[180:183], v[156:159], v[68:71]
    v_max_f32 v35, 0, v35
    v_mul_f32 v32, v32, v36
    v_mul_f32 v33, v33, v37
    v_mfma_f32_16x16x32_bf16 v[72:75], v[184:187], v[156:159], v[72:75]
    v_mul_f32 v34, v34, v38
    v_mul_f32 v35, v35, v39
    v_cvt_pk_bf16_f32 v128, v32, v33
    v_mfma_f32_16x16x32_bf16 v[76:79], v[188:191], v[156:159], v[76:79]
    v_cvt_pk_bf16_f32 v129, v34, v35
    v_max_f32 v40, 0, v40
    v_max_f32 v41, 0, v41
    s_waitcnt lgkmcnt(2)
    v_mfma_f32_16x16x32_bf16 v[80:83], v[168:171], v[160:163], v[80:83]
    v_max_f32 v42, 0, v42
    v_max_f32 v43, 0, v43
    v_mul_f32 v40, v40, v44
    v_mfma_f32_16x16x32_bf16 v[84:87], v[172:175], v[160:163], v[84:87]
    v_mul_f32 v41, v41, v45
    v_mul_f32 v42, v42, v46
    v_mul_f32 v43, v43, v47
    v_mfma_f32_16x16x32_bf16 v[88:91], v[176:179], v[160:163], v[88:91]
    v_cvt_pk_bf16_f32 v130, v40, v41
    v_cvt_pk_bf16_f32 v131, v42, v43
    v_max_f32 v48, 0, v48
    v_mfma_f32_16x16x32_bf16 v[92:95], v[180:183], v[160:163], v[92:95]
    v_max_f32 v49, 0, v49
    v_max_f32 v50, 0, v50
    v_max_f32 v51, 0, v51
    v_mfma_f32_16x16x32_bf16 v[96:99], v[184:187], v[160:163], v[96:99]
    v_mul_f32 v48, v48, v52
    v_mul_f32 v49, v49, v53
    v_mul_f32 v50, v50, v54
    v_mfma_f32_16x16x32_bf16 v[100:103], v[188:191], v[160:163], v[100:103]
    v_mul_f32 v51, v51, v55
    v_cvt_pk_bf16_f32 v132, v48, v49
    v_cvt_pk_bf16_f32 v133, v50, v51
    s_waitcnt lgkmcnt(0)
    v_mfma_f32_16x16x32_bf16 v[104:107], v[168:171], v[164:167], v[104:107]
    buffer_store_dwordx4 v[128:131], v20, s[4:7], 0 offen offset:0 sc1
    v_max_f32 v56, 0, v56
    v_max_f32 v57, 0, v57
    v_mfma_f32_16x16x32_bf16 v[108:111], v[172:175], v[164:167], v[108:111]
    v_max_f32 v58, 0, v58
    v_max_f32 v59, 0, v59
    v_mul_f32 v56, v56, v60
    v_mfma_f32_16x16x32_bf16 v[112:115], v[176:179], v[164:167], v[112:115]
    v_mul_f32 v57, v57, v61
    v_mul_f32 v58, v58, v62
    v_mul_f32 v59, v59, v63
    v_mfma_f32_16x16x32_bf16 v[116:119], v[180:183], v[164:167], v[116:119]
    v_cvt_pk_bf16_f32 v134, v56, v57
    v_cvt_pk_bf16_f32 v135, v58, v59
    v_max_f32 v64, 0, v64
    v_mfma_f32_16x16x32_bf16 v[120:123], v[184:187], v[164:167], v[120:123]
    v_max_f32 v65, 0, v65
    v_max_f32 v66, 0, v66
    v_max_f32 v67, 0, v67
    v_mfma_f32_16x16x32_bf16 v[124:127], v[188:191], v[164:167], v[124:127]
    v_mul_f32 v64, v64, v68
    v_mul_f32 v65, v65, v69
    v_mul_f32 v66, v66, v70
    v_mul_f32 v67, v67, v71
    v_cvt_pk_bf16_f32 v136, v64, v65
    v_cvt_pk_bf16_f32 v137, v66, v67
    v_max_f32 v72, 0, v72
    v_max_f32 v73, 0, v73
    v_max_f32 v74, 0, v74
    v_max_f32 v75, 0, v75
    v_mul_f32 v72, v72, v76
    v_mul_f32 v73, v73, v77
    v_mul_f32 v74, v74, v78
    v_mul_f32 v75, v75, v79
    v_cvt_pk_bf16_f32 v138, v72, v73
    v_cvt_pk_bf16_f32 v139, v74, v75
    buffer_store_dwordx4 v[134:137], v20, s[4:7], 0 offen offset:1024 sc1
    v_cndmask_b32 v8, v138, v132, s[38:39]
    v_cndmask_b32 v9, v139, v133, s[38:39]
    s_nop 0
    v_mov_b32_dpp v8, v8 quad_perm:[1,0,3,2] row_mask:0xf bank_mask:0xf
    v_mov_b32_dpp v9, v9 quad_perm:[1,0,3,2] row_mask:0xf bank_mask:0xf
    v_cndmask_b32 v4, v132, v8, s[38:39]
    v_cndmask_b32 v6, v8, v138, s[38:39]
    v_cndmask_b32 v5, v133, v9, s[38:39]
    v_cndmask_b32 v7, v9, v139, s[38:39]
    buffer_store_dwordx4 v[4:7], v21, s[4:7], 0 offen offset:0 sc1
    v_max_f32 v80, 0, v80
    v_max_f32 v81, 0, v81
    v_max_f32 v82, 0, v82
    v_max_f32 v83, 0, v83
    v_mul_f32 v80, v80, v84
    v_mul_f32 v81, v81, v85
    v_mul_f32 v82, v82, v86
    v_mul_f32 v83, v83, v87
    v_cvt_pk_bf16_f32 v140, v80, v81
    v_cvt_pk_bf16_f32 v141, v82, v83
    v_max_f32 v88, 0, v88
    v_max_f32 v89, 0, v89
    v_max_f32 v90, 0, v90
    v_max_f32 v91, 0, v91
    v_mul_f32 v88, v88, v92
    v_mul_f32 v89, v89, v93
    v_mul_f32 v90, v90, v94
    v_mul_f32 v91, v91, v95
    v_cvt_pk_bf16_f32 v142, v88, v89
    v_cvt_pk_bf16_f32 v143, v90, v91
    v_max_f32 v96, 0, v96
    v_max_f32 v97, 0, v97
    v_max_f32 v98, 0, v98
    v_max_f32 v99, 0, v99
    v_mul_f32 v96, v96, v100
    v_mul_f32 v97, v97, v101
    v_mul_f32 v98, v98, v102
    v_mul_f32 v99, v99, v103
    v_cvt_pk_bf16_f32 v144, v96, v97
    v_cvt_pk_bf16_f32 v145, v98, v99
    buffer_store_dwordx4 v[140:143], v20, s[4:7], 0 offen offset:2048 sc1
    s_nop 7
    v_max_f32 v104, 0, v104
    v_max_f32 v105, 0, v105
    v_max_f32 v106, 0, v106
    v_max_f32 v107, 0, v107
    v_mul_f32 v104, v104, v108
    v_mul_f32 v105, v105, v109
    v_mul_f32 v106, v106, v110
    v_mul_f32 v107, v107, v111
    v_cvt_pk_bf16_f32 v146, v104, v105
    v_cvt_pk_bf16_f32 v147, v106, v107
    v_max_f32 v112, 0, v112
    v_max_f32 v113, 0, v113
    v_max_f32 v114, 0, v114
    v_max_f32 v115, 0, v115
    v_mul_f32 v112, v112, v116
    v_mul_f32 v113, v113, v117
    v_mul_f32 v114, v114, v118
    v_mul_f32 v115, v115, v119
    v_cvt_pk_bf16_f32 v148, v112, v113
    v_cvt_pk_bf16_f32 v149, v114, v115
    v_max_f32 v120, 0, v120
    v_max_f32 v121, 0, v121
    v_max_f32 v122, 0, v122
    v_max_f32 v123, 0, v123
    v_mul_f32 v120, v120, v124
    v_mul_f32 v121, v121, v125
    v_mul_f32 v122, v122, v126
    v_mul_f32 v123, v123, v127
    v_cvt_pk_bf16_f32 v150, v120, v121
    v_cvt_pk_bf16_f32 v151, v122, v123
    buffer_store_dwordx4 v[146:149], v20, s[4:7], 0 offen offset:3072 sc1
    v_cndmask_b32 v10, v150, v144, s[38:39]
    v_cndmask_b32 v11, v151, v145, s[38:39]
    s_nop 0
    v_mov_b32_dpp v10, v10 quad_perm:[1,0,3,2] row_mask:0xf bank_mask:0xf
    v_mov_b32_dpp v11, v11 quad_perm:[1,0,3,2] row_mask:0xf bank_mask:0xf
    v_cndmask_b32 v28, v144, v10, s[38:39]
    v_cndmask_b32 v30, v10, v150, s[38:39]
    v_cndmask_b32 v29, v145, v11, s[38:39]
    v_cndmask_b32 v31, v11, v151, s[38:39]
    buffer_store_dwordx4 v[28:31], v21, s[4:7], 0 offen offset:2048 sc1
    s_mul_i32 s24, s40, 15360
    s_add_u32 s24, s24, 20480
    v_add_u32 v14, s24, v3
    s_mul_i32 s24, s40, 15360
    s_add_u32 s24, s24, 102400
    v_add_u32 v15, s24, v3
    s_waitcnt vmcnt(0)
    buffer_atomic_add v24, v23, s[4:7], 0 offen
    s_barrier
    ds_read_b128 v[136:139], v14 offset:0
    ds_read_b128 v[140:143], v14 offset:1024
    ds_read_b128 v[144:147], v14 offset:2048
    ds_read_b128 v[148:151], v14 offset:3072
    ds_read_b128 v[152:155], v14 offset:4096
    ds_read_b128 v[156:159], v14 offset:5120
    ds_read_b128 v[160:163], v14 offset:6144
    ds_read_b128 v[164:167], v14 offset:7168
    ds_read_b128 v[168:171], v14 offset:8192
    ds_read_b128 v[172:175], v14 offset:9216
    ds_read_b128 v[176:179], v14 offset:10240
    ds_read_b128 v[180:183], v14 offset:11264
    ds_read_b128 v[184:187], v14 offset:12288
    ds_read_b128 v[188:191], v14 offset:13312
    ds_read_b128 v[192:195], v14 offset:14336
    ds_read_b128 v[196:199], v15 offset:0
    ds_read_b128 v[200:203], v15 offset:1024
    ds_read_b128 v[204:207], v15 offset:2048
    ds_read_b128 v[208:211], v15 offset:3072
    ds_read_b128 v[212:215], v15 offset:4096
    ds_read_b128 v[216:219], v15 offset:5120
    ds_read_b128 v[220:223], v15 offset:6144
    ds_read_b128 v[224:227], v15 offset:7168
    ds_read_b128 v[228:231], v15 offset:8192
    ds_read_b128 v[232:235], v15 offset:9216
    ds_read_b128 v[236:239], v15 offset:10240
    ds_read_b128 v[240:243], v15 offset:11264
    ds_read_b128 v[244:247], v15 offset:12288
    ds_read_b128 v[248:251], v15 offset:13312
    ds_read_b128 v[252:255], v15 offset:14336
    s_cmp_lg_u32 s40, 0
    s_cbranch_scc1 K34_P2
    s_mov_b32 s27, 400000
K34_POLL:
    buffer_load_dword v27, v25, s[4:7], 0 offen sc1
    s_waitcnt vmcnt(0)
    v_cmp_le_u32 vcc, 16, v27
    s_nop 1
    s_cmp_eq_u64 vcc, -1
    s_cbranch_scc1 K34_P2
    s_sleep 1
    s_sub_u32 s27, s27, 1
    s_cmp_lg_u32 s27, 0
    s_cbranch_scc1 K34_POLL
    s_branch K34_P2
K3_LOADER:
    s_sub_u32 s14, s14, 4
    s_lshl_b32 s24, s14, 11
    s_mul_i32 s25, s14, 3072
    s_add_u32 s25, s25, 8192
    s_lshl_b32 s26, s14, 15
    v_add_u32 v4, s26, v3
    v_xor_b32 v8, 128, v4
    v_add_u32 v8, 15360, v8
    s_mul_i32 s26, s14, 3072
    v_add_u32 v5, s26, v3
    s_lshl_b32 s26, s3, 10
    s_add_u32 s26, s26, 20488192
    s_cmp_eq_u32 s14, 0
    s_cselect_b32 s26, s26, 0x7ffffff0
    v_mov_b32 v6, s26
    s_lshr_b32 s26, s2, 4
    s_lshl_b32 s26, s26, 7
    s_add_u32 s26, s26, 20508672
    v_mov_b32 v10, s26
    v_mov_b32 v11, 1
    v_lshlrev_b32 v12, 7, v2
    v_add_u32 v12, 20510720, v12
    s_and_b32 s26, s2, 15
    s_lshl_b32 s26, s26, 7
    s_add_u32 s26, s26, 20510720
    v_mov_b32 v13, s26
    v_mov_b32 v14, 1
    s_waitcnt vmcnt(0)
    s_barrier
    s_cmp_lg_u32 s14, 0
    s_cbranch_scc1 K34_GO
    s_mov_b64 exec, 1
    buffer_atomic_add v11, v10, s[4:7], 0 offen sc0
    s_waitcnt vmcnt(0)
    v_readfirstlane_b32 s26, v11
    s_mov_b64 exec, 0xffff
    s_cmp_lg_u32 s26, 15
    s_cbranch_scc1 K34_NL
    buffer_atomic_add v14, v12, s[4:7], 0 offen
K34_NL:
    s_mov_b64 exec, -1
    s_mov_b32 s35, 400000
SPIN_GH:
    buffer_load_dword v15, v13, s[4:7], 0 offen sc1
    s_waitcnt vmcnt(0)
    v_cmp_le_u32 vcc, 16, v15
    s_nop 1
    s_cmp_eq_u64 vcc, -1
    s_cbranch_scc1 SPUN_GH
    s_sleep 8
    s_sub_u32 s35, s35, 1
    s_cmp_lg_u32 s35, 0
    s_cbranch_scc1 SPIN_GH
SPUN_GH:
K34_GO:
    s_barrier
    s_add_u32 m0, s24, 0
    s_nop 0
    buffer_load_dwordx4 v4, s[4:7], s17 offen offset:0 lds
    buffer_load_dwordx4 v8, s[4:7], s17 offen offset:1024 lds
    s_add_u32 m0, s25, 0
    s_add_u32 s17, s17, 131072
    buffer_load_dwordx4 v5, s[4:7], s18 offen offset:0 lds
    buffer_load_dwordx4 v5, s[4:7], s18 offen offset:1024 lds
    buffer_load_dwordx4 v5, s[4:7], s18 offen offset:2048 lds
    s_add_u32 s18, s18, 12288
    s_add_u32 m0, s24, 20480
    s_nop 0
    buffer_load_dwordx4 v4, s[4:7], s17 offen offset:0 lds
    buffer_load_dwordx4 v8, s[4:7], s17 offen offset:1024 lds
    s_add_u32 m0, s25, 20480
    s_add_u32 s17, s17, 131072
    buffer_load_dwordx4 v5, s[4:7], s18 offen offset:0 lds
    buffer_load_dwordx4 v5, s[4:7], s18 offen offset:1024 lds
    buffer_load_dwordx4 v5, s[4:7], s18 offen offset:2048 lds
    s_add_u32 s18, s18, 12288
    s_add_u32 m0, s24, 40960
    s_nop 0
    buffer_load_dwordx4 v4, s[4:7], s17 offen offset:0 lds
    buffer_load_dwordx4 v8, s[4:7], s17 offen offset:1024 lds
    s_add_u32 m0, s25, 40960
    s_add_u32 s17, s17, 131072
    buffer_load_dwordx4 v5, s[4:7], s18 offen offset:0 lds
    buffer_load_dwordx4 v5, s[4:7], s18 offen offset:1024 lds
    buffer_load_dwordx4 v5, s[4:7], s18 offen offset:2048 lds
    s_add_u32 s18, s18, 12288
    s_bfe_u32 s26, s2, 0x10002
    s_mul_i32 s26, s26, 983040
    s_lshr_b32 s27, s2, 3
    s_mul_i32 s27, s27, 30720
    s_add_u32 s26, s26, s27
    s_mul_i32 s27, s14, 7680
    s_add_u32 s26, s26, s27
    s_add_u32 s26, s26, 12222464
    v_min_u32 v20, 59, v2
    v_lshlrev_b32 v20, 7, v20
    v_add_u32 v20, s26, v20
    s_bfe_u32 s54, s2, 0x10002
    s_mul_i32 s54, s54, 983040
    s_lshr_b32 s27, s2, 3
    s_mul_i32 s27, s27, 30720
    s_add_u32 s54, s54, s27
    s_mul_i32 s27, s14, 7680
    s_add_u32 s54, s54, s27
    s_add_u32 s54, s54, 12222464
    s_sub_u32 s50, s43, 108544
    s_mul_i32 s51, s14, 15360
    s_add_u32 s51, s51, 102400
    v_and_b32 v80, 1, v2
    v_cmp_eq_u32 s[38:39], 1, v80
    s_lshl_b32 s26, s3, 7
    s_lshl_b32 s27, s15, 3
    s_add_u32 s26, s26, s27
    s_lshl_b32 s27, s26, 3
    s_add_u32 s27, s27, 5341184
    s_mul_i32 s28, s14, 655360
    s_add_u32 s28, s28, s27
    v_lshrrev_b32 v82, 2, v2
    v_lshlrev_b32 v82, 14, v82
    v_and_b32 v81, 3, v2
    v_lshl_add_u32 v82, v81, 4, v82
    v_add_u32 v82, s28, v82
    v_add_u32 v83, 262144, v82
    v_add_u32 v84, 524288, v82
    v_mov_b32 v85, 0x7ffffff0
    v_cndmask_b32 v84, v85, v84, s[36:37]
    v_subrev_u32 v80, 256, v0
    v_cmp_gt_u32 vcc, 8, v80
    v_lshlrev_b32 v86, 3, v2
    s_add_u32 s27, s27, 2621440
    v_add_u32 v86, s27, v86
    v_cndmask_b32 v86, v85, v86, vcc
    s_lshl_b32 s26, s26, 2
    s_add_u32 s26, s26, 20480000
    v_lshlrev_b32 v87, 2, v2
    v_add_u32 v87, s26, v87
    v_cndmask_b32 v87, v85, v87, vcc
    s_lshl_b32 s26, s14, 6
    s_add_u32 s26, s26, 143360
    v_lshlrev_b32 v90, 4, v81
    v_add_u32 v90, s26, v90
    v_and_b32 v91, 7, v2
    v_lshlrev_b32 v91, 3, v91
    v_add_u32 v91, 143360, v91
    v_cmp_eq_u32 vcc, 256, v0
    v_mov_b32 v89, 1
    s_nop 0
    v_cndmask_b32 v88, v85, v6, vcc
    s_waitcnt vmcnt(10)
    s_barrier
    s_add_u32 m0, s24, 61440
    s_nop 0
    buffer_load_dwordx4 v4, s[4:7], s17 offen offset:0 lds
    buffer_load_dwordx4 v8, s[4:7], s17 offen offset:1024 lds
    s_add_u32 m0, s25, 61440
    s_add_u32 s17, s17, 131072
    buffer_load_dwordx4 v5, s[4:7], s18 offen offset:0 lds
    buffer_load_dwordx4 v5, s[4:7], s18 offen offset:1024 lds
    buffer_load_dwordx4 v5, s[4:7], s18 offen offset:2048 lds
    s_add_u32 s18, s18, 12288
    buffer_load_dwordx4 v[96:99], v82, s[4:7], 0 offen
    buffer_load_dwordx4 v[100:103], v83, s[4:7], 0 offen
    buffer_load_dwordx4 v[104:107], v84, s[4:7], 0 offen
    s_waitcnt vmcnt(13)
    s_barrier
    s_add_u32 m0, s24, 81920
    s_nop 0
    buffer_load_dwordx4 v4, s[4:7], s17 offen offset:0 lds
    buffer_load_dwordx4 v8, s[4:7], s17 offen offset:1024 lds
    s_add_u32 m0, s25, 81920
    s_add_u32 s17, s17, 131072
    buffer_load_dwordx4 v5, s[4:7], s18 offen offset:0 lds
    buffer_load_dwordx4 v5, s[4:7], s18 offen offset:1024 lds
    buffer_load_dwordx4 v5, s[4:7], s18 offen offset:2048 lds
    s_add_u32 s18, s18, 12288
    s_waitcnt vmcnt(13)
    s_barrier
    s_add_u32 m0, s24, 0
    s_nop 0
    buffer_load_dwordx4 v4, s[4:7], s17 offen offset:0 lds
    buffer_load_dwordx4 v8, s[4:7], s17 offen offset:1024 lds
    s_add_u32 m0, s25, 0
    s_add_u32 s17, s17, 131072
    buffer_load_dwordx4 v5, s[4:7], s18 offen offset:0 lds
    buffer_load_dwordx4 v5, s[4:7], s18 offen offset:1024 lds
    buffer_load_dwordx4 v5, s[4:7], s18 offen offset:2048 lds
    s_add_u32 s18, s18, 12288
    s_waitcnt vmcnt(13)
    s_barrier
    s_add_u32 m0, s24, 20480
    s_nop 0
    buffer_load_dwordx4 v4, s[4:7], s17 offen offset:0 lds
    buffer_load_dwordx4 v8, s[4:7], s17 offen offset:1024 lds
    s_add_u32 m0, s25, 20480
    s_add_u32 s17, s17, 131072
    buffer_load_dwordx4 v5, s[4:7], s18 offen offset:0 lds
    buffer_load_dwordx4 v5, s[4:7], s18 offen offset:1024 lds
    buffer_load_dwordx4 v5, s[4:7], s18 offen offset:2048 lds
    s_add_u32 s18, s18, 12288
    s_waitcnt vmcnt(15)
    v_lshlrev_b32 v108, 16, v96
    v_and_b32 v109, 0xffff0000, v96
    v_lshlrev_b32 v110, 16, v97
    v_and_b32 v111, 0xffff0000, v97
    v_lshlrev_b32 v120, 16, v98
    v_and_b32 v121, 0xffff0000, v98
    v_lshlrev_b32 v122, 16, v99
    v_and_b32 v123, 0xffff0000, v99
    v_lshlrev_b32 v112, 16, v100
    v_and_b32 v113, 0xffff0000, v100
    v_lshlrev_b32 v114, 16, v101
    v_and_b32 v115, 0xffff0000, v101
    v_lshlrev_b32 v124, 16, v102
    v_and_b32 v125, 0xffff0000, v102
    v_lshlrev_b32 v126, 16, v103
    v_and_b32 v127, 0xffff0000, v103
    v_lshlrev_b32 v116, 16, v104
    v_and_b32 v117, 0xffff0000, v104
    v_lshlrev_b32 v118, 16, v105
    v_and_b32 v119, 0xffff0000, v105
    v_lshlrev_b32 v128, 16, v106
    v_and_b32 v129, 0xffff0000, v106
    v_lshlrev_b32 v130, 16, v107
    v_and_b32 v131, 0xffff0000, v107
    v_add_f32 v132, v108, v109
    v_add_f32 v134, v120, v121
    v_add_f32 v132, v132, v110
    v_add_f32 v134, v134, v122
    v_add_f32 v132, v132, v111
    v_add_f32 v134, v134, v123
    v_add_f32 v132, v132, v112
    v_add_f32 v134, v134, v124
    v_add_f32 v132, v132, v113
    v_add_f32 v134, v134, v125
    v_add_f32 v132, v132, v114
    v_add_f32 v134, v134, v126
    v_add_f32 v132, v132, v115
    v_add_f32 v134, v134, v127
    v_add_f32 v132, v132, v116
    v_add_f32 v134, v134, v128
    v_add_f32 v132, v132, v117
    v_add_f32 v134, v134, v129
    v_add_f32 v132, v132, v118
    v_add_f32 v134, v134, v130
    v_add_f32 v132, v132, v119
    v_add_f32 v134, v134, v131
    s_nop 1
    v_add_f32_dpp v132, v132, v132 row_ror:4 row_mask:0xf bank_mask:0xf
    v_add_f32_dpp v134, v134, v134 row_ror:4 row_mask:0xf bank_mask:0xf
    s_nop 1
    v_add_f32_dpp v132, v132, v132 row_ror:8 row_mask:0xf bank_mask:0xf
    v_add_f32_dpp v134, v134, v134 row_ror:8 row_mask:0xf bank_mask:0xf
    v_mov_b32 v136, v132
    v_mov_b32 v137, v134
    s_nop 1
    v_permlane16_swap_b32 v132, v136
    v_permlane16_swap_b32 v134, v137
    s_nop 1
    v_add_f32 v132, v132, v136
    v_add_f32 v134, v134, v137
    v_mov_b32 v136, v132
    v_mov_b32 v137, v134
    s_nop 1
    v_permlane32_swap_b32 v132, v136
    v_permlane32_swap_b32 v134, v137
    s_nop 1
    v_add_f32 v132, v132, v136
    v_add_f32 v134, v134, v137
    v_mul_f32 v132, 0x3bcccccd, v132
    v_mul_f32 v134, 0x3bcccccd, v134
    v_cndmask_b32 v136, 0, v132, s[36:37]
    v_cndmask_b32 v137, 0, v134, s[36:37]
    v_sub_f32 v108, v108, v132
    v_sub_f32 v120, v120, v134
    v_sub_f32 v109, v109, v132
    v_sub_f32 v121, v121, v134
    v_sub_f32 v110, v110, v132
    v_sub_f32 v122, v122, v134
    v_sub_f32 v111, v111, v132
    v_sub_f32 v123, v123, v134
    s_waitcnt vmcnt(10)
    s_barrier
    s_add_u32 m0, s24, 40960
    s_nop 0
    buffer_load_dwordx4 v4, s[4:7], s17 offen offset:0 lds
    buffer_load_dwordx4 v8, s[4:7], s17 offen offset:1024 lds
    s_add_u32 m0, s25, 40960
    s_add_u32 s17, s17, 131072
    buffer_load_dwordx4 v5, s[4:7], s18 offen offset:0 lds
    buffer_load_dwordx4 v5, s[4:7], s18 offen offset:1024 lds
    buffer_load_dwordx4 v5, s[4:7], s18 offen offset:2048 lds
    s_add_u32 s18, s18, 12288
    v_sub_f32 v112, v112, v132
    v_sub_f32 v124, v124, v134
    v_sub_f32 v113, v113, v132
    v_sub_f32 v125, v125, v134
    v_sub_f32 v114, v114, v132
    v_sub_f32 v126, v126, v134
    v_sub_f32 v115, v115, v132
    v_sub_f32 v127, v127, v134
    v_sub_f32 v116, v116, v136
    v_sub_f32 v128, v128, v137
    v_sub_f32 v117, v117, v136
    v_sub_f32 v129, v129, v137
    v_sub_f32 v118, v118, v136
    v_sub_f32 v130, v130, v137
    v_sub_f32 v119, v119, v136
    v_sub_f32 v131, v131, v137
    v_mul_f32 v133, v108, v108
    v_mul_f32 v135, v120, v120
    v_fmac_f32 v133, v109, v109
    v_fmac_f32 v135, v121, v121
    v_fmac_f32 v133, v110, v110
    v_fmac_f32 v135, v122, v122
    v_fmac_f32 v133, v111, v111
    v_fmac_f32 v135, v123, v123
    v_fmac_f32 v133, v112, v112
    v_fmac_f32 v135, v124, v124
    v_fmac_f32 v133, v113, v113
    v_fmac_f32 v135, v125, v125
    v_fmac_f32 v133, v114, v114
    v_fmac_f32 v135, v126, v126
    v_fmac_f32 v133, v115, v115
    v_fmac_f32 v135, v127, v127
    v_fmac_f32 v133, v116, v116
    v_fmac_f32 v135, v128, v128
    v_fmac_f32 v133, v117, v117
    v_fmac_f32 v135, v129, v129
    v_fmac_f32 v133, v118, v118
    v_fmac_f32 v135, v130, v130
    v_fmac_f32 v133, v119, v119
    v_fmac_f32 v135, v131, v131
    s_nop 1
    v_add_f32_dpp v133, v133, v133 row_ror:4 row_mask:0xf bank_mask:0xf
    v_add_f32_dpp v135, v135, v135 row_ror:4 row_mask:0xf bank_mask:0xf
    s_nop 1
    v_add_f32_dpp v133, v133, v133 row_ror:8 row_mask:0xf bank_mask:0xf
    v_add_f32_dpp v135, v135, v135 row_ror:8 row_mask:0xf bank_mask:0xf
    v_mov_b32 v136, v133
    v_mov_b32 v137, v135
    s_nop 1
    v_permlane16_swap_b32 v133, v136
    v_permlane16_swap_b32 v135, v137
    s_nop 1
    v_add_f32 v133, v133, v136
    v_add_f32 v135, v135, v137
    v_mov_b32 v136, v133
    v_mov_b32 v137, v135
    s_nop 1
    v_permlane32_swap_b32 v133, v136
    v_permlane32_swap_b32 v135, v137
    s_nop 1
    v_add_f32 v133, v133, v136
    v_add_f32 v135, v135, v137
    ds_write_b128 v90, v[132:135]
    s_waitcnt lgkmcnt(0)
    s_add_u32 s55, s43, 4096
    buffer_load_dwordx4 v[152:155], v3, s[4:7], s55 offen offset:0
    s_waitcnt vmcnt(11)
    s_barrier
    s_add_u32 m0, s24, 61440
    s_nop 0
    buffer_load_dwordx4 v4, s[4:7], s17 offen offset:0 lds
    buffer_load_dwordx4 v8, s[4:7], s17 offen offset:1024 lds
    s_add_u32 m0, s25, 61440
    s_add_u32 s17, s17, 131072
    buffer_load_dwordx4 v5, s[4:7], s18 offen offset:0 lds
    buffer_load_dwordx4 v5, s[4:7], s18 offen offset:1024 lds
    buffer_load_dwordx4 v5, s[4:7], s18 offen offset:2048 lds
    s_add_u32 s18, s18, 12288
    ds_read_b64 v[96:97], v91 offset:0
    ds_read_b64 v[98:99], v91 offset:64
    ds_read_b64 v[100:101], v91 offset:128
    ds_read_b64 v[102:103], v91 offset:192
    s_waitcnt lgkmcnt(0)
    v_add_f32 v104, v96, v98
    v_add_f32 v105, v100, v102
    v_add_f32 v104, v104, v105
    v_mul_f32 v104, 0x3e800000, v104
    v_add_f32 v105, v97, v99
    v_add_f32 v101, v101, v103
    v_add_f32 v105, v105, v101
    v_sub_f32 v96, v96, v104
    v_sub_f32 v98, v98, v104
    v_sub_f32 v100, v100, v104
    v_sub_f32 v102, v102, v104
    v_mul_f32 v96, v96, v96
    v_fmac_f32 v96, v98, v98
    v_fmac_f32 v96, v100, v100
    v_fmac_f32 v96, v102, v102
    v_mul_f32 v96, 0x43200000, v96
    v_add_f32 v105, v105, v96
    v_mul_f32 v105, 0x3acccccd, v105
    v_cvt_pk_bf16_f32 v136, v104, v104
    v_cvt_pk_bf16_f32 v105, v105, v105
    v_xor_b32 v136, 0x80008000, v136
    v_lshlrev_b32 v105, 16, v105
    v_and_b32 v137, 0xffff, v136
    v_add_f32 v105, 0x3727c5ac, v105
    v_cvt_pk_bf16_f32 v105, v105, v105
    v_lshlrev_b32 v105, 16, v105
    v_sqrt_f32 v105, v105
    s_nop 0
    v_cvt_pk_bf16_f32 v105, v105, v105
    v_lshlrev_b32 v105, 16, v105
    v_rcp_f32 v105, v105
    s_nop 0
    v_mul_f32 v138, v105, v105
    buffer_store_dwordx2 v[136:137], v86, s[4:7], 0 offen sc1
    buffer_store_dword v138, v87, s[4:7], 0 offen sc1
    s_add_u32 s55, s43, 4096
    buffer_load_dwordx4 v[156:159], v3, s[4:7], s55 offen offset:1024
    s_waitcnt vmcnt(14)
    s_barrier
    s_add_u32 m0, s24, 81920
    s_nop 0
    buffer_load_dwordx4 v4, s[4:7], s17 offen offset:0 lds
    buffer_load_dwordx4 v8, s[4:7], s17 offen offset:1024 lds
    s_add_u32 m0, s25, 81920
    s_add_u32 s17, s17, 131072
    buffer_load_dwordx4 v5, s[4:7], s18 offen offset:0 lds
    buffer_load_dwordx4 v5, s[4:7], s18 offen offset:1024 lds
    buffer_load_dwordx4 v5, s[4:7], s18 offen offset:2048 lds
    s_add_u32 s18, s18, 12288
    s_add_u32 s55, s43, 4096
    buffer_load_dwordx4 v[160:163], v3, s[4:7], s55 offen offset:2048
    s_waitcnt vmcnt(15)
    s_barrier
    s_add_u32 m0, s24, 0
    s_nop 0
    buffer_load_dwordx4 v4, s[4:7], s17 offen offset:0 lds
    buffer_load_dwordx4 v8, s[4:7], s17 offen offset:1024 lds
    s_add_u32 m0, s25, 0
    s_add_u32 s17, s17, 131072
    buffer_load_dwordx4 v5, s[4:7], s18 offen offset:0 lds
    buffer_load_dwordx4 v5, s[4:7], s18 offen offset:1024 lds
    buffer_load_dwordx4 v5, s[4:7], s18 offen offset:2048 lds
    s_add_u32 s18, s18, 12288
    s_add_u32 s55, s43, 4096
    buffer_load_dwordx4 v[164:167], v3, s[4:7], s55 offen offset:3072
    s_waitcnt vmcnt(15)
    s_barrier
    s_add_u32 m0, s24, 20480
    s_nop 0
    buffer_load_dwordx4 v4, s[4:7], s17 offen offset:0 lds
    buffer_load_dwordx4 v8, s[4:7], s17 offen offset:1024 lds
    s_add_u32 m0, s25, 20480
    s_add_u32 s17, s17, 131072
    buffer_load_dwordx4 v5, s[4:7], s18 offen offset:0 lds
    buffer_load_dwordx4 v5, s[4:7], s18 offen offset:1024 lds
    buffer_load_dwordx4 v5, s[4:7], s18 offen offset:2048 lds
    s_add_u32 s18, s18, 12288
    s_add_u32 s55, s43, 8192
    buffer_load_dwordx4 v[168:171], v3, s[4:7], s55 offen offset:0
    s_waitcnt vmcnt(13)
    s_barrier
    s_add_u32 m0, s24, 40960
    s_nop 0
    buffer_load_dwordx4 v4, s[4:7], s17 offen offset:0 lds
    buffer_load_dwordx4 v8, s[4:7], s17 offen offset:1024 lds
    s_add_u32 m0, s25, 40960
    s_add_u32 s17, s17, 131072
    buffer_load_dwordx4 v5, s[4:7], s18 offen offset:0 lds
    buffer_load_dwordx4 v5, s[4:7], s18 offen offset:1024 lds
    buffer_load_dwordx4 v5, s[4:7], s18 offen offset:2048 lds
    s_add_u32 s18, s18, 12288
    s_add_u32 s55, s43, 8192
    buffer_load_dwordx4 v[172:175], v3, s[4:7], s55 offen offset:1024
    s_waitcnt vmcnt(13)
    s_barrier
    s_add_u32 m0, s24, 61440
    s_nop 0
    buffer_load_dwordx4 v4, s[4:7], s17 offen offset:0 lds
    buffer_load_dwordx4 v8, s[4:7], s17 offen offset:1024 lds
    s_add_u32 m0, s25, 61440
    s_add_u32 s17, s17, 131072
    buffer_load_dwordx4 v5, s[4:7], s18 offen offset:0 lds
    buffer_load_dwordx4 v5, s[4:7], s18 offen offset:1024 lds
    buffer_load_dwordx4 v5, s[4:7], s18 offen offset:2048 lds
    s_add_u32 s18, s18, 12288
    buffer_atomic_add v89, v88, s[4:7], 0 offen
    s_add_u32 s55, s43, 8192
    buffer_load_dwordx4 v[176:179], v3, s[4:7], s55 offen offset:2048
    s_waitcnt vmcnt(14)
    s_barrier
    s_add_u32 m0, s24, 81920
    s_nop 0
    buffer_load_dwordx4 v4, s[4:7], s17 offen offset:0 lds
    buffer_load_dwordx4 v8, s[4:7], s17 offen offset:1024 lds
    s_add_u32 m0, s25, 81920
    s_add_u32 s17, s17, 131072
    buffer_load_dwordx4 v5, s[4:7], s18 offen offset:0 lds
    buffer_load_dwordx4 v5, s[4:7], s18 offen offset:1024 lds
    buffer_load_dwordx4 v5, s[4:7], s18 offen offset:2048 lds
    s_add_u32 s18, s18, 12288
    s_add_u32 s55, s43, 8192
    buffer_load_dwordx4 v[180:183], v3, s[4:7], s55 offen offset:3072
    s_waitcnt vmcnt(14)
    s_barrier
    s_add_u32 m0, s24, 0
    s_nop 0
    buffer_load_dwordx4 v4, s[4:7], s17 offen offset:0 lds
    buffer_load_dwordx4 v8, s[4:7], s17 offen offset:1024 lds
    s_add_u32 m0, s25, 0
    s_add_u32 s17, s17, 131072
    buffer_load_dwordx4 v5, s[4:7], s18 offen offset:0 lds
    buffer_load_dwordx4 v5, s[4:7], s18 offen offset:1024 lds
    buffer_load_dwordx4 v5, s[4:7], s18 offen offset:2048 lds
    s_add_u32 s18, s18, 12288
    s_add_u32 s55, s43, 12288
    buffer_load_dwordx4 v[184:187], v3, s[4:7], s55 offen offset:0
    s_waitcnt vmcnt(14)
    s_barrier
    s_add_u32 m0, s24, 20480
    s_nop 0
    buffer_load_dwordx4 v4, s[4:7], s17 offen offset:0 lds
    buffer_load_dwordx4 v8, s[4:7], s17 offen offset:1024 lds
    s_add_u32 m0, s25, 20480
    s_add_u32 s17, s17, 131072
    buffer_load_dwordx4 v5, s[4:7], s18 offen offset:0 lds
    buffer_load_dwordx4 v5, s[4:7], s18 offen offset:1024 lds
    buffer_load_dwordx4 v5, s[4:7], s18 offen offset:2048 lds
    s_add_u32 s18, s18, 12288
    s_add_u32 s55, s43, 12288
    buffer_load_dwordx4 v[188:191], v3, s[4:7], s55 offen offset:1024
    s_waitcnt vmcnt(13)
    s_barrier
    s_add_u32 m0, s24, 40960
    s_nop 0
    buffer_load_dwordx4 v4, s[4:7], s17 offen offset:0 lds
    buffer_load_dwordx4 v8, s[4:7], s17 offen offset:1024 lds
    s_add_u32 m0, s25, 40960
    s_add_u32 s17, s17, 131072
    buffer_load_dwordx4 v5, s[4:7], s18 offen offset:0 lds
    buffer_load_dwordx4 v5, s[4:7], s18 offen offset:1024 lds
    buffer_load_dwordx4 v5, s[4:7], s18 offen offset:2048 lds
    s_add_u32 s18, s18, 12288
    s_add_u32 s55, s43, 12288
    buffer_load_dwordx4 v[192:195], v3, s[4:7], s55 offen offset:2048
    s_waitcnt vmcnt(13)
    s_barrier
    buffer_load_dword v7, v6, s[4:7], 0 offen sc1
    s_add_u32 m0, s24, 61440
    s_nop 0
    buffer_load_dwordx4 v4, s[4:7], s17 offen offset:0 lds
    buffer_load_dwordx4 v8, s[4:7], s17 offen offset:1024 lds
    s_add_u32 m0, s25, 61440
    s_add_u32 s17, s17, 131072
    buffer_load_dwordx4 v5, s[4:7], s18 offen offset:0 lds
    buffer_load_dwordx4 v5, s[4:7], s18 offen offset:1024 lds
    buffer_load_dwordx4 v5, s[4:7], s18 offen offset:2048 lds
    s_add_u32 s18, s18, 12288
    s_add_u32 s55, s43, 12288
    buffer_load_dwordx4 v[196:199], v3, s[4:7], s55 offen offset:3072
    s_waitcnt vmcnt(14)
    s_barrier
    s_add_u32 m0, s24, 81920
    s_nop 0
    buffer_load_dwordx4 v4, s[4:7], s17 offen offset:0 lds
    buffer_load_dwordx4 v8, s[4:7], s17 offen offset:1024 lds
    s_add_u32 m0, s25, 81920
    s_add_u32 s17, s17, 131072
    buffer_load_dwordx4 v5, s[4:7], s18 offen offset:0 lds
    buffer_load_dwordx4 v5, s[4:7], s18 offen offset:1024 lds
    buffer_load_dwordx4 v5, s[4:7], s18 offen offset:2048 lds
    s_add_u32 s18, s18, 12288
    s_add_u32 s55, s43, 16384
    buffer_load_dwordx4 v[200:203], v3, s[4:7], s55 offen offset:0
    s_waitcnt vmcnt(14)
    s_barrier
    s_waitcnt vmcnt(12)
    s_cmp_lg_u32 s14, 0
    s_cbranch_scc1 K3_READY
    v_readfirstlane_b32 s26, v7
    s_nop 1
    s_cmp_ge_u32 s26, 16
    s_cbranch_scc1 K3_READY
    s_movk_i32 s27, 2000
K3_POLL:
    buffer_load_dword v7, v6, s[4:7], 0 offen sc1
    s_waitcnt vmcnt(0)
    v_readfirstlane_b32 s26, v7
    s_nop 1
    s_cmp_ge_u32 s26, 16
    s_cbranch_scc1 K3_READY
    s_sleep 8
    s_sub_u32 s27, s27, 1
    s_cmp_lg_u32 s27, 0
    s_cbranch_scc1 K3_POLL
    s_lshl_b32 s26, s3, 10
    s_add_u32 s26, s26, 5341184
    v_lshlrev_b32 v14, 14, v2
    v_add_u32 v14, s26, v14
    v_lshlrev_b32 v15, 3, v2
    s_add_u32 s26, s26, 2621440
    v_add_u32 v15, s26, v15
    v_mov_b32 v13, 0x7ffffff0
    v_cmp_gt_u32 s[28:29], 2, v2
    s_mov_b32 s27, 0
K3_FB:
    v_add_u32 v10, s27, v14
    v_add_u32 v11, 1048576, v10
    v_add_u32 v12, 2097152, v10
    v_cndmask_b32 v12, v13, v12, s[36:37]
    v_add_u32 v16, s27, v15
    v_cndmask_b32 v16, v13, v16, s[28:29]
    buffer_load_dwordx4 v[32:35], v10, s[4:7], 0 offen
    buffer_load_dwordx4 v[36:39], v11, s[4:7], 0 offen
    buffer_load_dwordx4 v[40:43], v12, s[4:7], 0 offen
    s_waitcnt vmcnt(0)
    v_lshlrev_b32 v44, 16, v32
    v_and_b32 v45, 0xffff0000, v32
    v_lshlrev_b32 v46, 16, v33
    v_and_b32 v47, 0xffff0000, v33
    v_lshlrev_b32 v56, 16, v34
    v_and_b32 v57, 0xffff0000, v34
    v_lshlrev_b32 v58, 16, v35
    v_and_b32 v59, 0xffff0000, v35
    v_lshlrev_b32 v48, 16, v36
    v_and_b32 v49, 0xffff0000, v36
    v_lshlrev_b32 v50, 16, v37
    v_and_b32 v51, 0xffff0000, v37
    v_lshlrev_b32 v60, 16, v38
    v_and_b32 v61, 0xffff0000, v38
    v_lshlrev_b32 v62, 16, v39
    v_and_b32 v63, 0xffff0000, v39
    v_lshlrev_b32 v52, 16, v40
    v_and_b32 v53, 0xffff0000, v40
    v_lshlrev_b32 v54, 16, v41
    v_and_b32 v55, 0xffff0000, v41
    v_lshlrev_b32 v64, 16, v42
    v_and_b32 v65, 0xffff0000, v42
    v_lshlrev_b32 v66, 16, v43
    v_and_b32 v67, 0xffff0000, v43
    v_add_f32 v68, v44, v45
    v_add_f32 v70, v56, v57
    v_add_f32 v68, v68, v46
    v_add_f32 v70, v70, v58
    v_add_f32 v68, v68, v47
    v_add_f32 v70, v70, v59
    v_add_f32 v68, v68, v48
    v_add_f32 v70, v70, v60
    v_add_f32 v68, v68, v49
    v_add_f32 v70, v70, v61
    v_add_f32 v68, v68, v50
    v_add_f32 v70, v70, v62
    v_add_f32 v68, v68, v51
    v_add_f32 v70, v70, v63
    v_add_f32 v68, v68, v52
    v_add_f32 v70, v70, v64
    v_add_f32 v68, v68, v53
    v_add_f32 v70, v70, v65
    v_add_f32 v68, v68, v54
    v_add_f32 v70, v70, v66
    v_add_f32 v68, v68, v55
    v_add_f32 v70, v70, v67
    s_nop 1
    v_add_f32_dpp v68, v68, v68 quad_perm:[1,0,3,2] row_mask:0xf bank_mask:0xf
    v_add_f32_dpp v70, v70, v70 quad_perm:[1,0,3,2] row_mask:0xf bank_mask:0xf
    s_nop 1
    v_add_f32_dpp v68, v68, v68 quad_perm:[2,3,0,1] row_mask:0xf bank_mask:0xf
    v_add_f32_dpp v70, v70, v70 quad_perm:[2,3,0,1] row_mask:0xf bank_mask:0xf
    s_nop 1
    v_add_f32_dpp v68, v68, v68 row_half_mirror row_mask:0xf bank_mask:0xf
    v_add_f32_dpp v70, v70, v70 row_half_mirror row_mask:0xf bank_mask:0xf
    s_nop 1
    v_add_f32_dpp v68, v68, v68 row_mirror row_mask:0xf bank_mask:0xf
    v_add_f32_dpp v70, v70, v70 row_mirror row_mask:0xf bank_mask:0xf
    v_mov_b32 v69, v68
    v_mov_b32 v71, v70
    s_nop 1
    v_permlane16_swap_b32 v68, v69
    v_permlane16_swap_b32 v70, v71
    s_nop 1
    v_add_f32 v68, v68, v69
    v_add_f32 v70, v70, v71
    v_mov_b32 v69, v68
    v_mov_b32 v71, v70
    s_nop 1
    v_permlane32_swap_b32 v68, v69
    v_permlane32_swap_b32 v70, v71
    s_nop 1
    v_add_f32 v68, v68, v69
    v_add_f32 v70, v70, v71
    v_mul_f32 v68, 0x3acccccd, v68
    v_mul_f32 v70, 0x3acccccd, v70
    v_cndmask_b32 v69, 0, v68, s[36:37]
    v_cndmask_b32 v71, 0, v70, s[36:37]
    v_cndmask_b32 v75, v68, v70, s[38:39]
    v_sub_f32 v44, v44, v68
    v_sub_f32 v56, v56, v70
    v_sub_f32 v45, v45, v68
    v_sub_f32 v57, v57, v70
    v_sub_f32 v46, v46, v68
    v_sub_f32 v58, v58, v70
    v_sub_f32 v47, v47, v68
    v_sub_f32 v59, v59, v70
    v_sub_f32 v48, v48, v68
    v_sub_f32 v60, v60, v70
    v_sub_f32 v49, v49, v68
    v_sub_f32 v61, v61, v70
    v_sub_f32 v50, v50, v68
    v_sub_f32 v62, v62, v70
    v_sub_f32 v51, v51, v68
    v_sub_f32 v63, v63, v70
    v_sub_f32 v52, v52, v69
    v_sub_f32 v64, v64, v71
    v_sub_f32 v53, v53, v69
    v_sub_f32 v65, v65, v71
    v_sub_f32 v54, v54, v69
    v_sub_f32 v66, v66, v71
    v_sub_f32 v55, v55, v69
    v_sub_f32 v67, v67, v71
    v_mul_f32 v68, v44, v44
    v_mul_f32 v70, v56, v56
    v_fmac_f32 v68, v45, v45
    v_fmac_f32 v70, v57, v57
    v_fmac_f32 v68, v46, v46
    v_fmac_f32 v70, v58, v58
    v_fmac_f32 v68, v47, v47
    v_fmac_f32 v70, v59, v59
    v_fmac_f32 v68, v48, v48
    v_fmac_f32 v70, v60, v60
    v_fmac_f32 v68, v49, v49
    v_fmac_f32 v70, v61, v61
    v_fmac_f32 v68, v50, v50
    v_fmac_f32 v70, v62, v62
    v_fmac_f32 v68, v51, v51
    v_fmac_f32 v70, v63, v63
    v_fmac_f32 v68, v52, v52
    v_fmac_f32 v70, v64, v64
    v_fmac_f32 v68, v53, v53
    v_fmac_f32 v70, v65, v65
    v_fmac_f32 v68, v54, v54
    v_fmac_f32 v70, v66, v66
    v_fmac_f32 v68, v55, v55
    v_fmac_f32 v70, v67, v67
    s_nop 1
    v_add_f32_dpp v68, v68, v68 quad_perm:[1,0,3,2] row_mask:0xf bank_mask:0xf
    v_add_f32_dpp v70, v70, v70 quad_perm:[1,0,3,2] row_mask:0xf bank_mask:0xf
    s_nop 1
    v_add_f32_dpp v68, v68, v68 quad_perm:[2,3,0,1] row_mask:0xf bank_mask:0xf
    v_add_f32_dpp v70, v70, v70 quad_perm:[2,3,0,1] row_mask:0xf bank_mask:0xf
    s_nop 1
    v_add_f32_dpp v68, v68, v68 row_half_mirror row_mask:0xf bank_mask:0xf
    v_add_f32_dpp v70, v70, v70 row_half_mirror row_mask:0xf bank_mask:0xf
    s_nop 1
    v_add_f32_dpp v68, v68, v68 row_mirror row_mask:0xf bank_mask:0xf
    v_add_f32_dpp v70, v70, v70 row_mirror row_mask:0xf bank_mask:0xf
    v_mov_b32 v69, v68
    v_mov_b32 v71, v70
    s_nop 1
    v_permlane16_swap_b32 v68, v69
    v_permlane16_swap_b32 v70, v71
    s_nop 1
    v_add_f32 v68, v68, v69
    v_add_f32 v70, v70, v71
    v_mov_b32 v69, v68
    v_mov_b32 v71, v70
    s_nop 1
    v_permlane32_swap_b32 v68, v69
    v_permlane32_swap_b32 v70, v71
    s_nop 1
    v_add_f32 v68, v68, v69
    v_add_f32 v70, v70, v71
    v_cndmask_b32 v68, v68, v70, s[38:39]
    v_mul_f32 v68, 0x3acccccd, v68
    v_cvt_pk_bf16_f32 v72, v75, v75
    v_cvt_pk_bf16_f32 v68, v68, v68
    v_xor_b32 v72, 0x80008000, v72
    v_lshlrev_b32 v68, 16, v68
    v_and_b32 v73, 0xffff, v72
    v_add_f32 v68, 0x3727c5ac, v68
    v_cvt_pk_bf16_f32 v68, v68, v68
    v_lshlrev_b32 v68, 16, v68
    v_sqrt_f32 v68, v68
    s_nop 0
    v_cvt_pk_bf16_f32 v68, v68, v68
    v_lshlrev_b32 v68, 16, v68
    v_rcp_f32 v68, v68
    s_nop 0
    v_mul_f32 v74, v68, v68
    buffer_store_dwordx2 v[72:73], v16, s[4:7], 0 offen sc1
    s_add_u32 s27, s27, 16
    s_cmp_lt_u32 s27, 1024
    s_cbranch_scc1 K3_FB
    s_waitcnt vmcnt(0)
K3_READY:
    s_add_u32 m0, s24, 0
    s_nop 0
    buffer_load_dwordx4 v4, s[4:7], s17 offen offset:0 sc1 lds
    buffer_load_dwordx4 v8, s[4:7], s17 offen offset:1024 sc1 lds
    s_add_u32 m0, s25, 0
    s_add_u32 s17, s17, 131072
    buffer_load_dwordx4 v5, s[4:7], s18 offen offset:0 lds
    buffer_load_dwordx4 v5, s[4:7], s18 offen offset:1024 lds
    buffer_load_dwordx4 v5, s[4:7], s18 offen offset:2048 lds
    s_add_u32 s18, s18, 12288
    s_add_u32 s55, s43, 16384
    buffer_load_dwordx4 v[204:207], v3, s[4:7], s55 offen offset:1024
    s_add_u32 s55, s43, 16384
    buffer_load_dwordx4 v[208:211], v3, s[4:7], s55 offen offset:2048
    s_add_u32 s55, s43, 16384
    buffer_load_dwordx4 v[212:215], v3, s[4:7], s55 offen offset:3072
    s_add_u32 s55, s43, 20480
    buffer_load_dwordx4 v[216:219], v3, s[4:7], s55 offen offset:0
    s_waitcnt vmcnt(16)
    s_barrier
    s_add_u32 s55, s43, 20480
    buffer_load_dwordx4 v[220:223], v3, s[4:7], s55 offen offset:1024
    s_add_u32 s55, s43, 20480
    buffer_load_dwordx4 v[224:227], v3, s[4:7], s55 offen offset:2048
    s_add_u32 s55, s43, 20480
    buffer_load_dwordx4 v[228:231], v3, s[4:7], s55 offen offset:3072
    s_add_u32 s55, s43, 24576
    buffer_load_dwordx4 v[232:235], v3, s[4:7], s55 offen offset:0
    s_waitcnt vmcnt(14)
    s_barrier
    s_add_u32 s55, s43, 24576
    buffer_load_dwordx4 v[236:239], v3, s[4:7], s55 offen offset:1024
    s_add_u32 s55, s43, 24576
    buffer_load_dwordx4 v[240:243], v3, s[4:7], s55 offen offset:2048
    s_add_u32 s55, s43, 24576
    buffer_load_dwordx4 v[244:247], v3, s[4:7], s55 offen offset:3072
    s_add_u32 s55, s43, 28672
    buffer_load_dwordx4 v[248:251], v3, s[4:7], s55 offen offset:0
    s_waitcnt vmcnt(12)
    s_barrier
    s_add_u32 s55, s43, 28672
    buffer_load_dwordx4 v[252:255], v3, s[4:7], s55 offen offset:1024
    s_add_u32 s55, s43, 0
    buffer_load_dwordx4 v[136:139], v3, s[4:7], s55 offen offset:0
    s_add_u32 s55, s43, 0
    buffer_load_dwordx4 v[140:143], v3, s[4:7], s55 offen offset:1024
    s_add_u32 s55, s43, 0
    buffer_load_dwordx4 v[144:147], v3, s[4:7], s55 offen offset:2048
    s_add_u32 s55, s43, 0
    buffer_load_dwordx4 v[148:151], v3, s[4:7], s55 offen offset:3072
    s_add_u32 m0, s51, 0
    s_add_u32 s50, s50, 1024
    buffer_load_dwordx4 v3, s[4:7], s50 offen lds
    s_add_u32 m0, s51, 1024
    s_add_u32 s50, s50, 1024
    buffer_load_dwordx4 v3, s[4:7], s50 offen lds
    s_add_u32 m0, s51, 2048
    s_add_u32 s50, s50, 1024
    buffer_load_dwordx4 v3, s[4:7], s50 offen lds
    s_add_u32 m0, s51, 3072
    s_add_u32 s50, s50, 1024
    buffer_load_dwordx4 v3, s[4:7], s50 offen lds
    s_add_u32 m0, s51, 4096
    s_add_u32 s50, s50, 1024
    buffer_load_dwordx4 v3, s[4:7], s50 offen lds
    s_add_u32 m0, s51, 5120
    s_add_u32 s50, s50, 1024
    buffer_load_dwordx4 v3, s[4:7], s50 offen lds
    s_add_u32 m0, s51, 6144
    s_add_u32 s50, s50, 1024
    buffer_load_dwordx4 v3, s[4:7], s50 offen lds
    s_add_u32 m0, s51, 7168
    s_add_u32 s50, s50, 1024
    buffer_load_dwordx4 v3, s[4:7], s50 offen lds
    s_add_u32 m0, s51, 8192
    s_add_u32 s50, s50, 1024
    buffer_load_dwordx4 v3, s[4:7], s50 offen lds
    s_add_u32 m0, s51, 9216
    s_add_u32 s50, s50, 1024
    buffer_load_dwordx4 v3, s[4:7], s50 offen lds
    s_add_u32 m0, s51, 10240
    s_add_u32 s50, s50, 1024
    buffer_load_dwordx4 v3, s[4:7], s50 offen lds
    s_add_u32 m0, s51, 11264
    s_add_u32 s50, s50, 1024
    buffer_load_dwordx4 v3, s[4:7], s50 offen lds
    s_add_u32 m0, s51, 12288
    s_add_u32 s50, s50, 1024
    buffer_load_dwordx4 v3, s[4:7], s50 offen lds
    s_add_u32 m0, s51, 13312
    s_add_u32 s50, s50, 1024
    buffer_load_dwordx4 v3, s[4:7], s50 offen lds
    s_add_u32 m0, s51, 14336
    s_add_u32 s50, s50, 1024
    buffer_load_dwordx4 v3, s[4:7], s50 offen lds
    s_mul_i32 s26, s42, 245760
    s_mul_i32 s27, s14, 30720
    s_add_u32 s26, s26, s27
    s_add_u32 s26, s26, 12222464
    s_mul_i32 s27, s14, 15360
    s_add_u32 s27, s27, 20480
    s_add_u32 m0, s27, 0
    s_nop 0
    buffer_load_dwordx4 v3, s[4:7], s26 offen offset:0 lds
    buffer_load_dwordx4 v3, s[4:7], s26 offen offset:1024 lds
    buffer_load_dwordx4 v3, s[4:7], s26 offen offset:2048 lds
    buffer_load_dwordx4 v3, s[4:7], s26 offen offset:3072 lds
    s_add_u32 m0, s27, 4096
    s_add_u32 s26, s26, 4096
    buffer_load_dwordx4 v3, s[4:7], s26 offen offset:0 lds
    buffer_load_dwordx4 v3, s[4:7], s26 offen offset:1024 lds
    buffer_load_dwordx4 v3, s[4:7], s26 offen offset:2048 lds
    buffer_load_dwordx4 v3, s[4:7], s26 offen offset:3072 lds
    s_add_u32 m0, s27, 8192
    s_add_u32 s26, s26, 4096
    buffer_load_dwordx4 v3, s[4:7], s26 offen offset:0 lds
    buffer_load_dwordx4 v3, s[4:7], s26 offen offset:1024 lds
    buffer_load_dwordx4 v3, s[4:7], s26 offen offset:2048 lds
    buffer_load_dwordx4 v3, s[4:7], s26 offen offset:3072 lds
    s_add_u32 m0, s27, 12288
    s_add_u32 s26, s26, 4096
    buffer_load_dwordx4 v3, s[4:7], s26 offen offset:0 lds
    buffer_load_dwordx4 v3, s[4:7], s26 offen offset:1024 lds
    buffer_load_dwordx4 v3, s[4:7], s26 offen offset:2048 lds
    s_waitcnt vmcnt(0)
    s_barrier
K34_P2:
    s_and_b32 s14, s40, 3
    s_lshr_b32 s19, s40, 2
    s_mul_i32 s16, s41, 196608
    s_mul_i32 s17, s40, 24576
    s_add_u32 s16, s16, s17
    s_add_u32 s52, s16, 14188544
    s_mul_i32 s53, s40, 20480
    s_add_u32 s17, s14, 1
    s_and_b32 s17, s17, 3
    s_lshl_b32 s18, s17, 10
    s_add_u32 s44, s18, s52
    s_add_u32 s18, s18, s53
    v_add_u32 v8, s18, v3
    s_mul_i32 s17, s17, 5120
    s_add_u32 s17, s17, s53
    v_add_u32 v4, s17, v3
    s_add_u32 s17, s14, 2
    s_and_b32 s17, s17, 3
    s_lshl_b32 s18, s17, 10
    s_add_u32 s45, s18, s52
    s_add_u32 s18, s18, s53
    v_add_u32 v9, s18, v3
    s_mul_i32 s17, s17, 5120
    s_add_u32 s17, s17, s53
    v_add_u32 v5, s17, v3
    s_add_u32 s17, s14, 3
    s_and_b32 s17, s17, 3
    s_lshl_b32 s18, s17, 10
    s_add_u32 s46, s18, s52
    s_add_u32 s18, s18, s53
    v_add_u32 v10, s18, v3
    s_mul_i32 s17, s17, 5120
    s_add_u32 s17, s17, s53
    v_add_u32 v6, s17, v3
    s_add_u32 s17, s14, 4
    s_and_b32 s17, s17, 3
    s_lshl_b32 s18, s17, 10
    s_add_u32 s47, s18, s52
    s_add_u32 s18, s18, s53
    v_add_u32 v11, s18, v3
    s_mul_i32 s17, s17, 5120
    s_add_u32 s17, s17, s53
    v_add_u32 v7, s17, v3
    v_lshlrev_b32 v24, 3, v2
    v_sub_u32 v12, v8, v24
    v_sub_u32 v13, v9, v24
    v_sub_u32 v14, v10, v24
    v_sub_u32 v15, v11, v24
    v_and_b32 v24, 15, v2
    v_lshrrev_b32 v25, 4, v2
    s_lshl_b32 s16, s41, 6
    s_lshl_b32 s17, s14, 4
    s_add_u32 s16, s16, s17
    v_add_u32 v26, s16, v24
    v_lshlrev_b32 v23, 2, v26
    v_add_u32 v23, 20480000, v23
    v_lshlrev_b32 v21, 3, v26
    v_lshl_add_u32 v21, v25, 14, v21
    s_movk_i32 s17, 1280
    v_mul_u32_u24 v20, s17, v26
    v_lshl_add_u32 v20, v25, 3, v20
    s_mul_i32 s17, s42, 160
    v_add_u32 v20, s17, v20
    v_add_u32 v22, 8192, v3
    s_mul_i32 s30, s42, 327680
    s_add_u32 s30, s30, 5341184
    s_add_u32 s31, s30, 65536
    s_add_u32 s32, s31, 65536
    s_add_u32 s33, s32, 65536
    s_add_u32 s34, s33, 65536
    s_waitcnt lgkmcnt(0)
    s_barrier
    buffer_load_dwordx4 v[112:115], v3, s[4:7], s44 offen
    buffer_load_dwordx4 v[116:119], v3, s[4:7], s45 offen
    buffer_load_dwordx4 v[120:123], v3, s[4:7], s46 offen
    buffer_load_dwordx4 v[124:127], v3, s[4:7], s47 offen
    buffer_load_dwordx4 v[128:131], v22, s[4:7], s44 offen
    buffer_load_dwordx4 v[132:135], v22, s[4:7], s45 offen
    buffer_load_dwordx4 v[24:27], v22, s[4:7], s46 offen
    buffer_load_dwordx4 v[28:31], v22, s[4:7], s47 offen
    s_add_u32 m0, s53, 0
    s_add_u32 s16, s52, 4096
    buffer_load_dwordx4 v3, s[4:7], s16 offen offset:0 lds
    buffer_load_dwordx4 v3, s[4:7], s16 offen offset:1024 lds
    buffer_load_dwordx4 v3, s[4:7], s16 offen offset:2048 lds
    buffer_load_dwordx4 v3, s[4:7], s16 offen offset:3072 lds
    s_add_u32 m0, s53, 4096
    s_add_u32 s16, s52, 12288
    buffer_load_dwordx4 v3, s[4:7], s16 offen offset:0 lds
    buffer_load_dwordx4 v3, s[4:7], s16 offen offset:1024 lds
    buffer_load_dwordx4 v3, s[4:7], s16 offen offset:2048 lds
    buffer_load_dwordx4 v3, s[4:7], s16 offen offset:3072 lds
    s_waitcnt vmcnt(12)
    v_mfma_f32_16x16x32_bf16 v[32:35], v[136:139], v[112:115], 0
    v_mfma_f32_16x16x32_bf16 v[36:39], v[140:143], v[112:115], 0
    s_add_u32 m0, s53, 8192
    s_add_u32 s16, s52, 16384
    buffer_load_dwordx4 v3, s[4:7], s16 offen offset:0 lds
    v_mfma_f32_16x16x32_bf16 v[40:43], v[144:147], v[112:115], 0
    v_mfma_f32_16x16x32_bf16 v[44:47], v[148:151], v[112:115], 0
    v_mfma_f32_16x16x32_bf16 v[48:51], v[152:155], v[112:115], 0
    v_mfma_f32_16x16x32_bf16 v[52:55], v[136:139], v[116:119], 0
    buffer_load_dwordx4 v3, s[4:7], s16 offen offset:1024 lds
    v_mfma_f32_16x16x32_bf16 v[56:59], v[140:143], v[116:119], 0
    v_mfma_f32_16x16x32_bf16 v[60:63], v[144:147], v[116:119], 0
    v_mfma_f32_16x16x32_bf16 v[64:67], v[148:151], v[116:119], 0
    v_mfma_f32_16x16x32_bf16 v[68:71], v[152:155], v[116:119], 0
    buffer_load_dwordx4 v3, s[4:7], s16 offen offset:2048 lds
    v_mfma_f32_16x16x32_bf16 v[72:75], v[136:139], v[120:123], 0
    v_mfma_f32_16x16x32_bf16 v[76:79], v[140:143], v[120:123], 0
    v_mfma_f32_16x16x32_bf16 v[80:83], v[144:147], v[120:123], 0
    v_mfma_f32_16x16x32_bf16 v[84:87], v[148:151], v[120:123], 0
    buffer_load_dwordx4 v3, s[4:7], s16 offen offset:3072 lds
    v_mfma_f32_16x16x32_bf16 v[88:91], v[152:155], v[120:123], 0
    v_mfma_f32_16x16x32_bf16 v[92:95], v[136:139], v[124:127], 0
    v_mfma_f32_16x16x32_bf16 v[96:99], v[140:143], v[124:127], 0
    v_mfma_f32_16x16x32_bf16 v[100:103], v[144:147], v[124:127], 0
    v_mfma_f32_16x16x32_bf16 v[104:107], v[148:151], v[124:127], 0
    v_mfma_f32_16x16x32_bf16 v[108:111], v[152:155], v[124:127], 0
    s_waitcnt vmcnt(12)
    s_waitcnt vmcnt(8)
    ds_read_b64 v[112:113], v12 offset:0
    ds_read_b64 v[114:115], v12 offset:512
    ds_read_b64 v[116:117], v13 offset:0
    ds_read_b64 v[118:119], v13 offset:512
    ds_read_b64 v[120:121], v14 offset:0
    ds_read_b64 v[122:123], v14 offset:512
    ds_read_b64 v[124:125], v15 offset:0
    ds_read_b64 v[126:127], v15 offset:512
    v_mfma_f32_16x16x32_bf16 v[32:35], v[176:179], v[128:131], v[32:35]
    v_mfma_f32_16x16x32_bf16 v[36:39], v[180:183], v[128:131], v[36:39]
    s_add_u32 m0, s53, 12288
    s_add_u32 s16, s52, 20480
    buffer_load_dwordx4 v3, s[4:7], s16 offen offset:0 lds
    v_mfma_f32_16x16x32_bf16 v[40:43], v[184:187], v[128:131], v[40:43]
    v_mfma_f32_16x16x32_bf16 v[44:47], v[188:191], v[128:131], v[44:47]
    v_mfma_f32_16x16x32_bf16 v[48:51], v[192:195], v[128:131], v[48:51]
    v_mfma_f32_16x16x32_bf16 v[52:55], v[176:179], v[132:135], v[52:55]
    buffer_load_dwordx4 v3, s[4:7], s16 offen offset:1024 lds
    v_mfma_f32_16x16x32_bf16 v[56:59], v[180:183], v[132:135], v[56:59]
    v_mfma_f32_16x16x32_bf16 v[60:63], v[184:187], v[132:135], v[60:63]
    v_mfma_f32_16x16x32_bf16 v[64:67], v[188:191], v[132:135], v[64:67]
    v_mfma_f32_16x16x32_bf16 v[68:71], v[192:195], v[132:135], v[68:71]
    buffer_load_dwordx4 v3, s[4:7], s16 offen offset:2048 lds
    v_mfma_f32_16x16x32_bf16 v[72:75], v[176:179], v[24:27], v[72:75]
    v_mfma_f32_16x16x32_bf16 v[76:79], v[180:183], v[24:27], v[76:79]
    v_mfma_f32_16x16x32_bf16 v[80:83], v[184:187], v[24:27], v[80:83]
    v_mfma_f32_16x16x32_bf16 v[84:87], v[188:191], v[24:27], v[84:87]
    buffer_load_dwordx4 v3, s[4:7], s16 offen offset:3072 lds
    v_mfma_f32_16x16x32_bf16 v[88:91], v[192:195], v[24:27], v[88:91]
    v_mfma_f32_16x16x32_bf16 v[92:95], v[176:179], v[28:31], v[92:95]
    v_mfma_f32_16x16x32_bf16 v[96:99], v[180:183], v[28:31], v[96:99]
    v_mfma_f32_16x16x32_bf16 v[100:103], v[184:187], v[28:31], v[100:103]
    v_mfma_f32_16x16x32_bf16 v[104:107], v[188:191], v[28:31], v[104:107]
    v_mfma_f32_16x16x32_bf16 v[108:111], v[192:195], v[28:31], v[108:111]
    s_waitcnt vmcnt(8)
    ds_read_b128 v[128:131], v8 offset:4096
    ds_read_b128 v[132:135], v9 offset:4096
    ds_read_b128 v[24:27], v10 offset:4096
    ds_read_b128 v[28:31], v11 offset:4096
    s_waitcnt lgkmcnt(4)
    v_mfma_f32_16x16x32_bf16 v[32:35], v[156:159], v[112:115], v[32:35]
    v_mfma_f32_16x16x32_bf16 v[36:39], v[160:163], v[112:115], v[36:39]
    v_mfma_f32_16x16x32_bf16 v[40:43], v[164:167], v[112:115], v[40:43]
    v_mfma_f32_16x16x32_bf16 v[44:47], v[168:171], v[112:115], v[44:47]
    v_mfma_f32_16x16x32_bf16 v[48:51], v[172:175], v[112:115], v[48:51]
    v_mfma_f32_16x16x32_bf16 v[52:55], v[156:159], v[116:119], v[52:55]
    v_mfma_f32_16x16x32_bf16 v[56:59], v[160:163], v[116:119], v[56:59]
    v_mfma_f32_16x16x32_bf16 v[60:63], v[164:167], v[116:119], v[60:63]
    v_mfma_f32_16x16x32_bf16 v[64:67], v[168:171], v[116:119], v[64:67]
    v_mfma_f32_16x16x32_bf16 v[68:71], v[172:175], v[116:119], v[68:71]
    v_mfma_f32_16x16x32_bf16 v[72:75], v[156:159], v[120:123], v[72:75]
    v_mfma_f32_16x16x32_bf16 v[76:79], v[160:163], v[120:123], v[76:79]
    v_mfma_f32_16x16x32_bf16 v[80:83], v[164:167], v[120:123], v[80:83]
    v_mfma_f32_16x16x32_bf16 v[84:87], v[168:171], v[120:123], v[84:87]
    v_mfma_f32_16x16x32_bf16 v[88:91], v[172:175], v[120:123], v[88:91]
    v_mfma_f32_16x16x32_bf16 v[92:95], v[156:159], v[124:127], v[92:95]
    v_mfma_f32_16x16x32_bf16 v[96:99], v[160:163], v[124:127], v[96:99]
    v_mfma_f32_16x16x32_bf16 v[100:103], v[164:167], v[124:127], v[100:103]
    v_mfma_f32_16x16x32_bf16 v[104:107], v[168:171], v[124:127], v[104:107]
    v_mfma_f32_16x16x32_bf16 v[108:111], v[172:175], v[124:127], v[108:111]
    s_waitcnt vmcnt(4)
    ds_read_b64 v[112:113], v12 offset:8192
    ds_read_b64 v[114:115], v12 offset:8704
    ds_read_b64 v[116:117], v13 offset:8192
    ds_read_b64 v[118:119], v13 offset:8704
    ds_read_b64 v[120:121], v14 offset:8192
    ds_read_b64 v[122:123], v14 offset:8704
    ds_read_b64 v[124:125], v15 offset:8192
    ds_read_b64 v[126:127], v15 offset:8704
    s_waitcnt lgkmcnt(8)
    v_mfma_f32_16x16x32_bf16 v[32:35], v[196:199], v[128:131], v[32:35]
    v_mfma_f32_16x16x32_bf16 v[36:39], v[200:203], v[128:131], v[36:39]
    v_mfma_f32_16x16x32_bf16 v[40:43], v[204:207], v[128:131], v[40:43]
    v_mfma_f32_16x16x32_bf16 v[44:47], v[208:211], v[128:131], v[44:47]
    v_mfma_f32_16x16x32_bf16 v[48:51], v[212:215], v[128:131], v[48:51]
    v_mfma_f32_16x16x32_bf16 v[52:55], v[196:199], v[132:135], v[52:55]
    v_mfma_f32_16x16x32_bf16 v[56:59], v[200:203], v[132:135], v[56:59]
    v_mfma_f32_16x16x32_bf16 v[60:63], v[204:207], v[132:135], v[60:63]
    v_mfma_f32_16x16x32_bf16 v[64:67], v[208:211], v[132:135], v[64:67]
    v_mfma_f32_16x16x32_bf16 v[68:71], v[212:215], v[132:135], v[68:71]
    v_mfma_f32_16x16x32_bf16 v[72:75], v[196:199], v[24:27], v[72:75]
    v_mfma_f32_16x16x32_bf16 v[76:79], v[200:203], v[24:27], v[76:79]
    v_mfma_f32_16x16x32_bf16 v[80:83], v[204:207], v[24:27], v[80:83]
    v_mfma_f32_16x16x32_bf16 v[84:87], v[208:211], v[24:27], v[84:87]
    v_mfma_f32_16x16x32_bf16 v[88:91], v[212:215], v[24:27], v[88:91]
    v_mfma_f32_16x16x32_bf16 v[92:95], v[196:199], v[28:31], v[92:95]
    v_mfma_f32_16x16x32_bf16 v[96:99], v[200:203], v[28:31], v[96:99]
    v_mfma_f32_16x16x32_bf16 v[100:103], v[204:207], v[28:31], v[100:103]
    v_mfma_f32_16x16x32_bf16 v[104:107], v[208:211], v[28:31], v[104:107]
    v_mfma_f32_16x16x32_bf16 v[108:111], v[212:215], v[28:31], v[108:111]
    buffer_load_dwordx2 v[136:137], v21, s[4:7], s30 offen
    buffer_load_dwordx2 v[138:139], v21, s[4:7], s31 offen
    buffer_load_dwordx2 v[140:141], v21, s[4:7], s32 offen
    buffer_load_dwordx2 v[142:143], v21, s[4:7], s33 offen
    buffer_load_dwordx2 v[144:145], v21, s[4:7], s34 offen
    buffer_load_dword v18, v23, s[4:7], 0 offen
    s_waitcnt vmcnt(6)
    ds_read_b128 v[128:131], v8 offset:12288
    ds_read_b128 v[132:135], v9 offset:12288
    ds_read_b128 v[24:27], v10 offset:12288
    ds_read_b128 v[28:31], v11 offset:12288
    s_waitcnt lgkmcnt(4)
    v_mfma_f32_16x16x32_bf16 v[32:35], v[216:219], v[112:115], v[32:35]
    v_mfma_f32_16x16x32_bf16 v[36:39], v[220:223], v[112:115], v[36:39]
    v_mfma_f32_16x16x32_bf16 v[40:43], v[224:227], v[112:115], v[40:43]
    v_mfma_f32_16x16x32_bf16 v[44:47], v[228:231], v[112:115], v[44:47]
    v_mfma_f32_16x16x32_bf16 v[48:51], v[232:235], v[112:115], v[48:51]
    v_mfma_f32_16x16x32_bf16 v[52:55], v[216:219], v[116:119], v[52:55]
    v_mfma_f32_16x16x32_bf16 v[56:59], v[220:223], v[116:119], v[56:59]
    v_mfma_f32_16x16x32_bf16 v[60:63], v[224:227], v[116:119], v[60:63]
    v_mfma_f32_16x16x32_bf16 v[64:67], v[228:231], v[116:119], v[64:67]
    v_mfma_f32_16x16x32_bf16 v[68:71], v[232:235], v[116:119], v[68:71]
    v_mfma_f32_16x16x32_bf16 v[72:75], v[216:219], v[120:123], v[72:75]
    v_mfma_f32_16x16x32_bf16 v[76:79], v[220:223], v[120:123], v[76:79]
    v_mfma_f32_16x16x32_bf16 v[80:83], v[224:227], v[120:123], v[80:83]
    v_mfma_f32_16x16x32_bf16 v[84:87], v[228:231], v[120:123], v[84:87]
    v_mfma_f32_16x16x32_bf16 v[88:91], v[232:235], v[120:123], v[88:91]
    v_mfma_f32_16x16x32_bf16 v[92:95], v[216:219], v[124:127], v[92:95]
    v_mfma_f32_16x16x32_bf16 v[96:99], v[220:223], v[124:127], v[96:99]
    v_mfma_f32_16x16x32_bf16 v[100:103], v[224:227], v[124:127], v[100:103]
    v_mfma_f32_16x16x32_bf16 v[104:107], v[228:231], v[124:127], v[104:107]
    v_mfma_f32_16x16x32_bf16 v[108:111], v[232:235], v[124:127], v[108:111]
    s_waitcnt lgkmcnt(0)
    v_mfma_f32_16x16x32_bf16 v[32:35], v[236:239], v[128:131], v[32:35]
    v_mfma_f32_16x16x32_bf16 v[36:39], v[240:243], v[128:131], v[36:39]
    v_mfma_f32_16x16x32_bf16 v[40:43], v[244:247], v[128:131], v[40:43]
    v_mfma_f32_16x16x32_bf16 v[44:47], v[248:251], v[128:131], v[44:47]
    v_mfma_f32_16x16x32_bf16 v[48:51], v[252:255], v[128:131], v[48:51]
    v_mfma_f32_16x16x32_bf16 v[52:55], v[236:239], v[132:135], v[52:55]
    v_mfma_f32_16x16x32_bf16 v[56:59], v[240:243], v[132:135], v[56:59]
    v_mfma_f32_16x16x32_bf16 v[60:63], v[244:247], v[132:135], v[60:63]
    v_mfma_f32_16x16x32_bf16 v[64:67], v[248:251], v[132:135], v[64:67]
    ds_write_b128 v4, v[32:35] offset:0
    v_mfma_f32_16x16x32_bf16 v[68:71], v[252:255], v[132:135], v[68:71]
    ds_write_b128 v4, v[36:39] offset:1024
    v_mfma_f32_16x16x32_bf16 v[72:75], v[236:239], v[24:27], v[72:75]
    ds_write_b128 v4, v[40:43] offset:2048
    v_mfma_f32_16x16x32_bf16 v[76:79], v[240:243], v[24:27], v[76:79]
    ds_write_b128 v4, v[44:47] offset:3072
    v_mfma_f32_16x16x32_bf16 v[80:83], v[244:247], v[24:27], v[80:83]
    ds_write_b128 v4, v[48:51] offset:4096
    v_mfma_f32_16x16x32_bf16 v[84:87], v[248:251], v[24:27], v[84:87]
    ds_write_b128 v5, v[52:55] offset:0
    v_mfma_f32_16x16x32_bf16 v[88:91], v[252:255], v[24:27], v[88:91]
    ds_write_b128 v5, v[56:59] offset:1024
    v_mfma_f32_16x16x32_bf16 v[92:95], v[236:239], v[28:31], v[92:95]
    ds_write_b128 v5, v[60:63] offset:2048
    v_mfma_f32_16x16x32_bf16 v[96:99], v[240:243], v[28:31], v[96:99]
    ds_write_b128 v5, v[64:67] offset:3072
    v_mfma_f32_16x16x32_bf16 v[100:103], v[244:247], v[28:31], v[100:103]
    ds_write_b128 v5, v[68:71] offset:4096
    v_mfma_f32_16x16x32_bf16 v[104:107], v[248:251], v[28:31], v[104:107]
    ds_write_b128 v6, v[72:75] offset:0
    v_mfma_f32_16x16x32_bf16 v[108:111], v[252:255], v[28:31], v[108:111]
    ds_write_b128 v6, v[76:79] offset:1024
    ds_write_b128 v6, v[80:83] offset:2048
    ds_write_b128 v6, v[84:87] offset:3072
    ds_write_b128 v6, v[88:91] offset:4096
    s_cmp_eq_u32 s19, 1
    s_cbranch_scc1 K34_OWN
    s_nop 4
    ds_write_b128 v7, v[92:95] offset:0
    ds_write_b128 v7, v[96:99] offset:1024
    ds_write_b128 v7, v[100:103] offset:2048
    ds_write_b128 v7, v[104:107] offset:3072
    ds_write_b128 v7, v[108:111] offset:4096
    s_waitcnt lgkmcnt(0)
    s_barrier
    s_endpgm
K34_OWN:
    s_mul_i32 s16, s14, 5120
    s_add_u32 s17, s40, 1
    s_and_b32 s17, s17, 7
    s_mul_i32 s17, s17, 20480
    s_add_u32 s17, s17, s16
    v_add_u32 v8, s17, v3
    s_add_u32 s17, s40, 2
    s_and_b32 s17, s17, 7
    s_mul_i32 s17, s17, 20480
    s_add_u32 s17, s17, s16
    v_add_u32 v9, s17, v3
    s_add_u32 s17, s40, 3
    s_and_b32 s17, s17, 7
    s_mul_i32 s17, s17, 20480
    s_add_u32 s17, s17, s16
    v_add_u32 v10, s17, v3
    s_add_u32 s17, s40, 4
    s_and_b32 s17, s17, 7
    s_mul_i32 s17, s17, 20480
    s_add_u32 s17, s17, s16
    v_add_u32 v11, s17, v3
    s_add_u32 s17, s40, 5
    s_and_b32 s17, s17, 7
    s_mul_i32 s17, s17, 20480
    s_add_u32 s17, s17, s16
    v_add_u32 v12, s17, v3
    s_add_u32 s17, s40, 6
    s_and_b32 s17, s17, 7
    s_mul_i32 s17, s17, 20480
    s_add_u32 s17, s17, s16
    v_add_u32 v13, s17, v3
    s_add_u32 s17, s40, 7
    s_and_b32 s17, s17, 7
    s_mul_i32 s17, s17, 20480
    s_add_u32 s17, s17, s16
    v_add_u32 v14, s17, v3
    s_waitcnt vmcnt(0)
    v_lshlrev_b32 v112, 16, v136
    v_and_b32 v113, 0xffff0000, v136
    v_lshlrev_b32 v114, 16, v137
    v_and_b32 v115, 0xffff0000, v137
    v_lshlrev_b32 v116, 16, v138
    v_and_b32 v117, 0xffff0000, v138
    v_lshlrev_b32 v118, 16, v139
    v_and_b32 v119, 0xffff0000, v139
    v_lshlrev_b32 v120, 16, v140
    v_and_b32 v121, 0xffff0000, v140
    v_lshlrev_b32 v122, 16, v141
    v_and_b32 v123, 0xffff0000, v141
    v_lshlrev_b32 v124, 16, v142
    v_and_b32 v125, 0xffff0000, v142
    v_lshlrev_b32 v126, 16, v143
    v_and_b32 v127, 0xffff0000, v143
    v_lshlrev_b32 v128, 16, v144
    v_and_b32 v129, 0xffff0000, v144
    v_lshlrev_b32 v130, 16, v145
    v_and_b32 v131, 0xffff0000, v145
    s_waitcnt lgkmcnt(0)
    s_barrier
    ds_read_b128 v[32:35], v8 offset:0
    ds_read_b128 v[36:39], v9 offset:0
    ds_read_b128 v[40:43], v10 offset:0
    ds_read_b128 v[44:47], v11 offset:0
    ds_read_b128 v[48:51], v12 offset:0
    ds_read_b128 v[52:55], v13 offset:0
    ds_read_b128 v[56:59], v14 offset:0
    ds_read_b128 v[60:63], v8 offset:1024
    ds_read_b128 v[64:67], v9 offset:1024
    ds_read_b128 v[68:71], v10 offset:1024
    ds_read_b128 v[72:75], v11 offset:1024
    ds_read_b128 v[76:79], v12 offset:1024
    ds_read_b128 v[80:83], v13 offset:1024
    ds_read_b128 v[84:87], v14 offset:1024
    s_waitcnt lgkmcnt(7)
    v_pk_add_f32 v[92:93], v[92:93], v[32:33]
    v_pk_add_f32 v[36:37], v[36:37], v[40:41]
    v_pk_add_f32 v[44:45], v[44:45], v[48:49]
    v_pk_add_f32 v[52:53], v[52:53], v[56:57]
    v_pk_add_f32 v[94:95], v[94:95], v[34:35]
    v_pk_add_f32 v[38:39], v[38:39], v[42:43]
    v_pk_add_f32 v[46:47], v[46:47], v[50:51]
    v_pk_add_f32 v[54:55], v[54:55], v[58:59]
    v_pk_add_f32 v[92:93], v[92:93], v[36:37]
    v_pk_add_f32 v[44:45], v[44:45], v[52:53]
    v_pk_add_f32 v[94:95], v[94:95], v[38:39]
    v_pk_add_f32 v[46:47], v[46:47], v[54:55]
    v_pk_add_f32 v[92:93], v[92:93], v[44:45]
    v_pk_add_f32 v[94:95], v[94:95], v[46:47]
    ds_read_b128 v[32:35], v8 offset:2048
    ds_read_b128 v[36:39], v9 offset:2048
    ds_read_b128 v[40:43], v10 offset:2048
    ds_read_b128 v[44:47], v11 offset:2048
    ds_read_b128 v[48:51], v12 offset:2048
    ds_read_b128 v[52:55], v13 offset:2048
    ds_read_b128 v[56:59], v14 offset:2048
    v_fma_f32 v112, v92, v18, v112
    v_fma_f32 v113, v93, v18, v113
    v_fma_f32 v114, v94, v18, v114
    v_fma_f32 v115, v95, v18, v115
    v_cvt_pk_bf16_f32 v132, v112, v113
    v_cvt_pk_bf16_f32 v133, v114, v115
    global_store_dwordx2 v20, v[132:133], s[48:49] offset:0
    s_waitcnt lgkmcnt(7)
    v_pk_add_f32 v[96:97], v[96:97], v[60:61]
    v_pk_add_f32 v[64:65], v[64:65], v[68:69]
    v_pk_add_f32 v[72:73], v[72:73], v[76:77]
    v_pk_add_f32 v[80:81], v[80:81], v[84:85]
    v_pk_add_f32 v[98:99], v[98:99], v[62:63]
    v_pk_add_f32 v[66:67], v[66:67], v[70:71]
    v_pk_add_f32 v[74:75], v[74:75], v[78:79]
    v_pk_add_f32 v[82:83], v[82:83], v[86:87]
    v_pk_add_f32 v[96:97], v[96:97], v[64:65]
    v_pk_add_f32 v[72:73], v[72:73], v[80:81]
    v_pk_add_f32 v[98:99], v[98:99], v[66:67]
    v_pk_add_f32 v[74:75], v[74:75], v[82:83]
    v_pk_add_f32 v[96:97], v[96:97], v[72:73]
    v_pk_add_f32 v[98:99], v[98:99], v[74:75]
    ds_read_b128 v[60:63], v8 offset:3072
    ds_read_b128 v[64:67], v9 offset:3072
    ds_read_b128 v[68:71], v10 offset:3072
    ds_read_b128 v[72:75], v11 offset:3072
    ds_read_b128 v[76:79], v12 offset:3072
    ds_read_b128 v[80:83], v13 offset:3072
    ds_read_b128 v[84:87], v14 offset:3072
    v_fma_f32 v116, v96, v18, v116
    v_fma_f32 v117, v97, v18, v117
    v_fma_f32 v118, v98, v18, v118
    v_fma_f32 v119, v99, v18, v119
    v_cvt_pk_bf16_f32 v134, v116, v117
    v_cvt_pk_bf16_f32 v135, v118, v119
    global_store_dwordx2 v20, v[134:135], s[48:49] offset:32
    s_waitcnt lgkmcnt(7)
    v_pk_add_f32 v[100:101], v[100:101], v[32:33]
    v_pk_add_f32 v[36:37], v[36:37], v[40:41]
    v_pk_add_f32 v[44:45], v[44:45], v[48:49]
    v_pk_add_f32 v[52:53], v[52:53], v[56:57]
    v_pk_add_f32 v[102:103], v[102:103], v[34:35]
    v_pk_add_f32 v[38:39], v[38:39], v[42:43]
    v_pk_add_f32 v[46:47], v[46:47], v[50:51]
    v_pk_add_f32 v[54:55], v[54:55], v[58:59]
    v_pk_add_f32 v[100:101], v[100:101], v[36:37]
    v_pk_add_f32 v[44:45], v[44:45], v[52:53]
    v_pk_add_f32 v[102:103], v[102:103], v[38:39]
    v_pk_add_f32 v[46:47], v[46:47], v[54:55]
    v_pk_add_f32 v[100:101], v[100:101], v[44:45]
    v_pk_add_f32 v[102:103], v[102:103], v[46:47]
    ds_read_b128 v[32:35], v8 offset:4096
    ds_read_b128 v[36:39], v9 offset:4096
    ds_read_b128 v[40:43], v10 offset:4096
    ds_read_b128 v[44:47], v11 offset:4096
    ds_read_b128 v[48:51], v12 offset:4096
    ds_read_b128 v[52:55], v13 offset:4096
    ds_read_b128 v[56:59], v14 offset:4096
    v_fma_f32 v120, v100, v18, v120
    v_fma_f32 v121, v101, v18, v121
    v_fma_f32 v122, v102, v18, v122
    v_fma_f32 v123, v103, v18, v123
    v_cvt_pk_bf16_f32 v136, v120, v121
    v_cvt_pk_bf16_f32 v137, v122, v123
    global_store_dwordx2 v20, v[136:137], s[48:49] offset:64
    s_waitcnt lgkmcnt(7)
    v_pk_add_f32 v[104:105], v[104:105], v[60:61]
    v_pk_add_f32 v[64:65], v[64:65], v[68:69]
    v_pk_add_f32 v[72:73], v[72:73], v[76:77]
    v_pk_add_f32 v[80:81], v[80:81], v[84:85]
    v_pk_add_f32 v[106:107], v[106:107], v[62:63]
    v_pk_add_f32 v[66:67], v[66:67], v[70:71]
    v_pk_add_f32 v[74:75], v[74:75], v[78:79]
    v_pk_add_f32 v[82:83], v[82:83], v[86:87]
    v_pk_add_f32 v[104:105], v[104:105], v[64:65]
    v_pk_add_f32 v[72:73], v[72:73], v[80:81]
    v_pk_add_f32 v[106:107], v[106:107], v[66:67]
    v_pk_add_f32 v[74:75], v[74:75], v[82:83]
    v_pk_add_f32 v[104:105], v[104:105], v[72:73]
    v_pk_add_f32 v[106:107], v[106:107], v[74:75]
    v_fma_f32 v124, v104, v18, v124
    v_fma_f32 v125, v105, v18, v125
    v_fma_f32 v126, v106, v18, v126
    v_fma_f32 v127, v107, v18, v127
    v_cvt_pk_bf16_f32 v138, v124, v125
    v_cvt_pk_bf16_f32 v139, v126, v127
    global_store_dwordx2 v20, v[138:139], s[48:49] offset:96
    s_waitcnt lgkmcnt(0)
    v_pk_add_f32 v[108:109], v[108:109], v[32:33]
    v_pk_add_f32 v[36:37], v[36:37], v[40:41]
    v_pk_add_f32 v[44:45], v[44:45], v[48:49]
    v_pk_add_f32 v[52:53], v[52:53], v[56:57]
    v_pk_add_f32 v[110:111], v[110:111], v[34:35]
    v_pk_add_f32 v[38:39], v[38:39], v[42:43]
    v_pk_add_f32 v[46:47], v[46:47], v[50:51]
    v_pk_add_f32 v[54:55], v[54:55], v[58:59]
    v_pk_add_f32 v[108:109], v[108:109], v[36:37]
    v_pk_add_f32 v[44:45], v[44:45], v[52:53]
    v_pk_add_f32 v[110:111], v[110:111], v[38:39]
    v_pk_add_f32 v[46:47], v[46:47], v[54:55]
    v_pk_add_f32 v[108:109], v[108:109], v[44:45]
    v_pk_add_f32 v[110:111], v[110:111], v[46:47]
    v_fma_f32 v128, v108, v18, v128
    v_fma_f32 v129, v109, v18, v129
    v_fma_f32 v130, v110, v18, v130
    v_fma_f32 v131, v111, v18, v131
    v_cvt_pk_bf16_f32 v140, v128, v129
    v_cvt_pk_bf16_f32 v141, v130, v131
    global_store_dwordx2 v20, v[140:141], s[48:49] offset:128
K3_END:
    s_endpgm
.section .rodata,"a"
.p2align 6
.amdhsa_kernel sequential_preLN__ssm_conv_h3__glu_gated_reglu__prompt_kernel
  .amdhsa_next_free_vgpr 256
  .amdhsa_next_free_sgpr 60
  .amdhsa_accum_offset 256
  .amdhsa_group_segment_fixed_size 0
  .amdhsa_kernarg_size 104
  .amdhsa_user_sgpr_count 2
  .amdhsa_user_sgpr_kernarg_segment_ptr 1
  .amdhsa_system_sgpr_workgroup_id_x 1
  .amdhsa_float_denorm_mode_32 3
.end_amdhsa_kernel
```
